```python
import torch

def _softmax(x, axis=-1):
    return torch.softmax(x, dim=axis)
def _gelu(x):
    return torch.nn.functional.gelu(x, approximate="tanh")
def _silu(x):
    return torch.nn.functional.silu(x)
def _sigmoid(x):
    return torch.sigmoid(x)
def _layernorm(x, axis=-1, eps=1e-5):
    m = x.mean(dim=axis, keepdim=True)
    v = x.var(dim=axis, keepdim=True, unbiased=False)
    return (x - m) / torch.sqrt(v + eps)
def _scatter_add(tgt, idx, src, axis=0):
    return tgt.clone().index_add_(axis, idx, src)
def _segment_sum(src, seg, n):
    out = torch.zeros((n,) + src.shape[1:], dtype=src.dtype)
    return out.index_add_(0, seg, src)
def _pad(x, pw):
    flat = tuple(v for pair in reversed(pw) for v in pair)
    return torch.nn.functional.pad(x, flat)

kernel_name = 'recurrent_scan__sliding_local_dilated__swiglu_ffn__prompt'

def setup_inputs():

    _w = (lambda a: (lambda t: t.to(torch.bfloat16) if t.is_floating_point() else t)(torch.as_tensor(a)))
    def _A_setup():
        B, S, D = 1, 2048, 640
        return {
            "x": _w((lambda *s: torch.randn(*s, dtype=torch.bfloat16) * 0.05)(B, S, D)),
            "wqkv": _w((lambda *s: torch.randn(*s, dtype=torch.bfloat16) * 0.05)(D, 3 * D)),
            "wo": _w((lambda *s: torch.randn(*s, dtype=torch.bfloat16) * 0.05)(D, D)),
        }
    _A_in = _A_setup()

    def _B_setup():
        B, S, D, F = 1, 2048, 640, 1536
        return {
            "x": _w((lambda *s: torch.randn(*s, dtype=torch.bfloat16) * 0.05)(B, S, D)),
            "w_gate": _w((lambda *s: torch.randn(*s, dtype=torch.bfloat16) * 0.05)(D, F)),
            "w_up": _w((lambda *s: torch.randn(*s, dtype=torch.bfloat16) * 0.05)(D, F)),
            "w_down": _w((lambda *s: torch.randn(*s, dtype=torch.bfloat16) * 0.05)(F, D)),
        }
    _B_in = _B_setup()

    return {
        "A_x": _A_in["x"],
        "A_wqkv": _A_in["wqkv"],
        "A_wo": _A_in["wo"],
        "B_x": _B_in["x"],
        "B_w_gate": _B_in["w_gate"],
        "B_w_up": _B_in["w_up"],
        "B_w_down": _B_in["w_down"],
    }

def reference(A_x, A_wqkv, A_wo, B_x, B_w_gate, B_w_up, B_w_down):
    def _A_ref(x, wqkv, wo):
        B, S, D = x.shape
        H = 32; Dh = D // H
        W, dil = 8, 2
        qkv = (lambda x, *d: x.permute(*d))((x @ wqkv).reshape(B, S, 3, H, Dh), 2, 0, 3, 1, 4)
        q, k, v = qkv[0], qkv[1], qkv[2]
        scale = Dh ** -0.5
        pos = torch.arange(S)
        off = torch.arange(W) * dil
        idx = pos[:, None] - off[None, :]
        mask = idx >= 0
        idx_c = torch.where(mask, idx, 0).reshape(-1)
        kg = k[:, :, idx_c, :].reshape(B, H, S, W, Dh)
        vg = v[:, :, idx_c, :].reshape(B, H, S, W, Dh)
        logits = torch.einsum("bhsd,bhswd->bhsw", q, kg) * scale
        logits = torch.where(mask[None, None, :, :], logits, -1e9)
        attn = _softmax(logits, axis=-1)
        o = torch.einsum("bhsw,bhswd->bhsd", attn, vg)
        return (lambda x, *d: x.permute(*d))(o, 0, 2, 1, 3).reshape(B, S, D) @ wo

    def _B_ref(x, w_gate, w_up, w_down):
        g = _silu(x @ w_gate)
        u = x @ w_up
        return (g * u) @ w_down

    x = A_x
    xn = _layernorm(x, axis=-1)
    s = _A_ref(xn, A_wqkv, A_wo)
    g = _silu(_B_ref(xn, B_w_gate, B_w_up, B_w_down))
    return x + s * g
```

```asm
; @launch grid=(256,1,1) block=(256,1,1) lds=163840
.amdgcn_target "amdgcn-amd-amdhsa--gfx950"
.text
.globl recurrent_scan__sliding_local_dilated__swiglu_ffn__prompt_kernel
.p2align 8
.type recurrent_scan__sliding_local_dilated__swiglu_ffn__prompt_kernel,@function
recurrent_scan__sliding_local_dilated__swiglu_ffn__prompt_kernel:
    s_load_dwordx2 s[4:5], s[0:1], 0
    s_cmpk_ge_u32 s2, 256
    s_cbranch_scc1 K_end
    s_getpc_b64 s[68:69]
    s_lshr_b32 s72, s2, 3
    v_lshl_add_u32 v1, s72, 8, v0
    v_lshlrev_b32 v1, 2, v1
    global_load_dword v56, v1, s[68:69]
    s_load_dwordx2 s[16:17], s[0:1], 72
    s_load_dwordx2 s[8:9], s[0:1], 8
    v_lshrrev_b32 v2, 6, v0
    s_and_b32 s73, s72, 7
    v_and_b32 v0, 63, v0
    s_and_b32 s72, s2, 2
    v_readfirstlane_b32 s46, v2
    s_lshl2_add_u32 s49, s72, s73
    s_lshr_b32 s71, s2, 6
    s_add_u32 s70, s71, s73
    s_and_b32 s70, s70, 3
    s_mulk_i32 s70, 320
    s_add_u32 s70, s70, 64
    v_lshrrev_b32 v1, 3, v0
    v_and_b32 v2, 7, v0
    v_lshrrev_b32 v3, 1, v1
    v_xor_b32 v4, v2, v3
    s_and_b32 s24, s70, 0x780
    v_mul_u32_u24 v5, 1280, v1
    v_lshl_add_u32 v40, v4, 4, v5
    v_xor_b32 v41, 64, v40
    s_lshl_b32 s41, s46, 12
    s_lshl2_add_u32 s70, s49, s46
    s_mul_i32 s45, s70, 40960
    s_mov_b32 s6, 2621440
    s_mov_b32 s7, 0x20000
    s_waitcnt lgkmcnt(0)
    s_add_u32 m0, s41, 0
    s_add_u32 s39, s24, s45
    buffer_load_dwordx4 v40, s[4:7], s39 offen offset:0 lds
    s_addk_i32 s39, 9216
    buffer_load_dwordx4 v41, s[4:7], s39 offen offset:1024 lds
    s_addk_i32 s39, 9216
    buffer_load_dwordx4 v40, s[4:7], s39 offen offset:2048 lds
    s_addk_i32 s39, 9216
    buffer_load_dwordx4 v41, s[4:7], s39 offen offset:3072 lds
    s_and_b32 s70, s2, 5
    s_add_u32 s70, s70, 1
    s_lshr_b32 s70, s70, 1
    s_lshl2_add_u32 s50, s70, s71
    v_lshlrev_b32 v3, 1, v3
    v_xor_b32 v4, v2, v3
    v_lshlrev_b32 v4, 4, v4
    v_add_u32 v129, v5, v4
    v_and_b32 v6, 4, v1
    v_add_u32 v6, v6, v1
    v_mul_u32_u24 v5, 3840, v6
    v_add_u32 v5, v5, v4
    s_lshr_b32 s47, s46, 1
    s_and_b32 s48, s46, 1
    s_lshl1_add_u32 s70, s50, s47
    s_lshl_b32 s70, s70, 7
    s_mul_i32 s71, s48, 122880
    s_add_u32 s42, s70, s71
    s_cmp_eq_u32 s50, 15
    s_cselect_b32 s10, 0, 2457600
    s_mov_b32 s11, s7
    s_add_u32 m0, s41, 65536
    s_mul_i32 s39, s24, 1920
    s_add_u32 s39, s39, s42
    buffer_load_dwordx4 v5, s[8:11], s39 offen offset:0 lds
    s_addk_i32 s39, 14336
    buffer_load_dwordx4 v5, s[8:11], s39 offen offset:1024 lds
    s_add_u32 s39, s39, 45056
    buffer_load_dwordx4 v5, s[8:11], s39 offen offset:2048 lds
    s_addk_i32 s39, 14336
    buffer_load_dwordx4 v5, s[8:11], s39 offen offset:3072 lds
    s_cmp_lg_u32 s50, 15
    s_cbranch_scc1 K_nz
    s_mov_b32 s18, 268435456
    s_mov_b32 s19, 0x20000
    s_lshl_b32 s73, s49, 2
    s_add_u32 s73, s73, s46
    s_lshl_b32 s73, s73, 10
    s_add_u32 s70, s73, 22020096
    v_lshlrev_b32 v8, 4, v0
    v_mov_b32 v140, 0
    v_mov_b32 v141, 0
    v_mov_b32 v142, 0
    v_mov_b32 v143, 0
    buffer_store_dwordx4 v[140:143], v8, s[16:19], s70 offen sc1
    s_add_u32 s70, s70, 65536
    buffer_store_dwordx4 v[140:143], v8, s[16:19], s70 offen sc1
    s_add_u32 s70, s70, 65536
    buffer_store_dwordx4 v[140:143], v8, s[16:19], s70 offen sc1
    s_add_u32 s70, s70, 65536
    buffer_store_dwordx4 v[140:143], v8, s[16:19], s70 offen sc1
    s_add_u32 s70, s70, 65536
    buffer_store_dwordx4 v[140:143], v8, s[16:19], s70 offen sc1
    s_add_u32 s70, s70, 65536
    buffer_store_dwordx4 v[140:143], v8, s[16:19], s70 offen sc1
    s_add_u32 s70, s70, 65536
K_nz:
    s_load_dwordx4 s[60:63], s[0:1], 32
    s_load_dwordx2 s[64:65], s[0:1], 16
    s_load_dwordx2 s[66:67], s[0:1], 48
    s_load_dwordx4 s[76:79], s[0:1], 56
    s_add_u32 s71, s24, 128
    s_sub_u32 s70, s71, 1280
    s_min_u32 s25, s71, s70
    s_add_u32 s71, s25, 128
    s_sub_u32 s70, s71, 1280
    s_min_u32 s26, s71, s70
    s_add_u32 s71, s26, 128
    s_sub_u32 s70, s71, 1280
    s_min_u32 s27, s71, s70
    s_add_u32 s71, s27, 128
    s_sub_u32 s70, s71, 1280
    s_min_u32 s28, s71, s70
    s_add_u32 s71, s28, 128
    s_sub_u32 s70, s71, 1280
    s_min_u32 s29, s71, s70
    s_add_u32 s71, s29, 128
    s_sub_u32 s70, s71, 1280
    s_min_u32 s30, s71, s70
    s_add_u32 s71, s30, 128
    s_sub_u32 s70, s71, 1280
    s_min_u32 s31, s71, s70
    s_add_u32 s71, s31, 128
    s_sub_u32 s70, s71, 1280
    s_min_u32 s32, s71, s70
    s_add_u32 s71, s32, 128
    s_sub_u32 s70, s71, 1280
    s_min_u32 s33, s71, s70
    v_mul_u32_u24 v7, 3072, v6
    v_add_u32 v60, v7, v4
    s_cmp_eq_u32 s47, 0
    s_waitcnt lgkmcnt(0)
    s_cselect_b32 s12, s60, s62
    s_cselect_b32 s13, s61, s63
    s_cselect_b64 s[82:83], 0, -1
    s_mov_b32 s14, 1966080
    s_mov_b32 s15, 0x20000
    s_mov_b32 s18, 268435456
    s_mov_b32 s19, 0x20000
    s_mov_b32 s20, s16
    s_mov_b32 s21, s17
    s_cmp_eq_u32 s50, 15
    s_cselect_b32 s22, 0, s18
    s_mov_b32 s23, 0x20000
    s_cmp_eq_u32 s50, 15
    s_cselect_b32 s72, 0, 0x80000000
    s_lshl_b32 s73, s49, 12
    s_add_u32 s73, s73, 22020096
    s_lshl_b32 s70, s50, 4
    s_add_u32 s70, s70, s47
    s_lshl3_add_u32 s70, s70, s48
    s_add_u32 s69, s70, s73
    s_lshl_b32 s70, s50, 2
    s_add_u32 s70, s70, s46
    s_lshl_b32 s70, s70, 2
    s_add_u32 s70, s70, s73
    s_add_u32 s70, s70, 2048
    v_min_u32 v134, 1, v0
    v_lshlrev_b32 v134, 31, v134
    v_or_b32 v3, s70, v134
    s_lshl_b32 s70, s49, 2
    s_add_u32 s70, s70, s46
    s_lshl_b32 s70, s70, 2
    s_or_b32 s70, s70, s72
    v_or_b32 v135, s70, v134
    s_mov_b32 s40, 0x20000
    s_lshl_b32 s70, s46, 14
    s_add_u32 s70, s70, 22022144
    v_lshrrev_b32 v8, 4, v0
    v_and_b32 v9, 15, v0
    v_lshl_add_u32 v8, v8, 12, s70
    v_lshl_add_u32 v61, v9, 4, v8
    v_lshlrev_b32 v138, 2, v0
    s_lshl_b32 s70, s50, 7
    s_mul_i32 s71, s48, 98304
    s_add_u32 s43, s70, s71
    s_lshl_b32 s70, s50, 11
    s_lshl_b32 s71, s48, 16
    s_add_u32 s70, s70, s71
    s_add_u32 s44, s70, 20611072
    s_cmp_eq_u32 s47, 0
    s_cselect_b32 s34, s24, s25
    s_cselect_b32 s35, s26, s27
    s_cselect_b32 s36, s28, s29
    s_cselect_b32 s37, s30, s31
    s_cselect_b32 s38, s32, s33
    s_lshl_b32 s34, s34, 10
    s_lshl_b32 s35, s35, 10
    s_lshl_b32 s36, s36, 10
    s_lshl_b32 s37, s37, 10
    s_lshl_b32 s38, s38, 10
    s_cmp_lt_u32 s50, 5
    s_cselect_b32 s59, 0x3ea52b5c, 1.0
    s_mov_b32 s58, 0xc08f1bbd
    s_cselect_b32 s58, s58, 0xbfb8aa3b
    s_lshl_b32 s70, s46, 8
    s_add_u32 s70, s70, s2
    s_cmp_lt_u32 s70, 1000
    s_cselect_b32 s3, 0, 0x80000000
    s_min_u32 s70, s70, 999
    s_lshl_b32 s71, s70, 12
    s_add_u32 s1, s71, 17825792
    s_mul_i32 s71, s70, 6554
    s_lshr_b32 s71, s71, 16
    s_mul_i32 s72, s71, 10
    s_sub_u32 s72, s70, s72
    s_lshl_b32 s72, s72, 7
    s_mul_i32 s73, s71, 40960
    s_sub_u32 s75, s71, 48
    s_mul_i32 s74, s75, 51200
    s_cmp_lt_u32 s71, 48
    s_cselect_b32 s64, s66, s64
    s_cselect_b32 s65, s67, s65
    s_mov_b32 s66, 1966080
    s_cselect_b32 s66, s66, 819200
    s_mov_b32 s67, 0x20000
    s_cselect_b32 s73, s73, s74
    s_movk_i32 s0, 9216
    s_cselect_b32 s81, s0, 24576
    s_cselect_b32 s0, s0, 4294950912
    s_sub_u32 s75, s71, 64
    s_mul_i32 s74, s75, 204800
    s_add_u32 s74, s74, 20480
    s_cmp_lt_u32 s71, 64
    s_cselect_b32 s73, s73, s74
    s_cselect_b32 s0, s0, 75776
    s_cselect_b32 s75, 0, 46080
    s_add_u32 s80, s73, s72
    s_and_b32 s72, s71, 1
    s_mul_i32 s72, s72, 20480
    s_sub_u32 s72, s80, s72
    s_cmp_lt_u32 s71, 32
    s_cselect_b32 s80, s72, s80
    s_cselect_b32 s0, 29696, s0
    s_sub_u32 s74, s70, 680
    s_bitcmp1_b32 s74, 3
    s_cselect_b32 s60, s62, s60
    s_cselect_b32 s61, s63, s61
    s_lshr_b32 s72, s74, 4
    s_mul_i32 s72, s72, 98304
    s_and_b32 s74, s74, 7
    s_lshl_b32 s74, s74, 7
    s_add_u32 s72, s72, s74
    s_add_u32 s72, s72, 2048
    s_cmp_lt_u32 s70, 680
    s_cselect_b32 s80, s80, s72
    s_cselect_b32 s64, s64, s60
    s_cselect_b32 s65, s65, s61
    s_cselect_b32 s66, s66, 1966080
    s_cselect_b32 s81, s81, 11264
    s_cselect_b32 s0, s0, 35840
    s_cselect_b32 s75, s75, 12288
    s_cselect_b32 s74, 0, 1792
    s_mov_b32 s60, s78
    s_mov_b32 s61, s79
    s_mov_b32 s62, 256
    s_mov_b32 s63, 0x20000
    v_lshrrev_b32 v8, 5, v0
    v_mad_u32_u24 v129, v1, s74, v129
    v_or_b32 v129, s3, v129
    v_mad_u32_u24 v128, v8, s75, v129
    v_bfe_u32 v9, v0, 2, 3
    v_and_b32 v10, 3, v0
    v_lshrrev_b32 v11, 1, v9
    v_lshlrev_b32 v11, 5, v11
    v_lshl_add_u32 v11, v10, 3, v11
    v_lshl_add_u32 v11, v9, 7, v11
    v_lshl_add_u32 v11, v8, 11, v11
    s_add_u32 s71, s41, 147456
    v_add_u32 v129, s71, v11
    v_xor_b32 v130, 32, v129
    v_xor_b32 v131, 64, v129
    v_xor_b32 v132, 96, v129
    s_lshl_b32 s70, s48, 1
    s_add_u32 s70, s70, s47
    s_lshl_b32 s71, s70, 5
    v_xor_b32 v1, s71, v11
    v_xor_b32 v2, 32, v1
    v_and_b32 v9, 15, v0
    v_lshrrev_b32 v10, 4, v0
    v_lshrrev_b32 v11, 1, v9
    v_xor_b32 v11, v11, v10
    v_lshlrev_b32 v11, 4, v11
    v_lshl_add_u32 v11, v9, 7, v11
    v_add_u32 v36, s41, v11
    v_xor_b32 v37, 0x1000, v36
    v_xor_b32 v38, 64, v36
    v_xor_b32 v39, 64, v37
    v_lshlrev_b32 v62, 4, v0
    v_or_b32 v133, s3, v62
    v_and_b32 v11, 31, v0
    v_lshlrev_b32 v11, 4, v11
    v_lshl_add_u32 v6, v8, 10, v11
    s_lshl_b32 s70, s70, 6
    s_add_u32 s70, s70, 159744
    v_lshlrev_b32 v10, 4, v10
    v_add_u32 v7, s70, v10
    v_xor_b32 v63, 64, v7
    v_mov_b32 v24, 0x3f803f80
    v_mov_b32 v25, 0x3f803f80
    v_mov_b32 v26, 0x3f803f80
    v_mov_b32 v27, 0x3f803f80
    v_add_u32 v1, 65536, v1
    v_add_u32 v2, 65536, v2
    s_add_u32 m0, s41, 16384
    s_add_u32 s39, s25, s45
    buffer_load_dwordx4 v40, s[4:7], s39 offen offset:0 lds
    s_add_u32 s39, s39, 9216
    buffer_load_dwordx4 v41, s[4:7], s39 offen offset:1024 lds
    s_add_u32 s39, s39, 9216
    buffer_load_dwordx4 v40, s[4:7], s39 offen offset:2048 lds
    s_add_u32 s39, s39, 9216
    buffer_load_dwordx4 v41, s[4:7], s39 offen offset:3072 lds
    s_add_u32 m0, s41, 81920
    s_mul_i32 s39, s25, 1920
    s_add_u32 s39, s39, s42
    buffer_load_dwordx4 v5, s[8:11], s39 offen offset:0 lds
    s_add_u32 s39, s39, 14336
    buffer_load_dwordx4 v5, s[8:11], s39 offen offset:1024 lds
    s_add_u32 s39, s39, 45056
    buffer_load_dwordx4 v5, s[8:11], s39 offen offset:2048 lds
    s_add_u32 s39, s39, 14336
    buffer_load_dwordx4 v5, s[8:11], s39 offen offset:3072 lds
    s_waitcnt vmcnt(8)
    s_barrier
    ds_read_b128 v[192:195], v36 offset:0
    ds_read_b128 v[196:199], v36 offset:2048
    ds_read_b128 v[200:203], v37 offset:0
    ds_read_b128 v[204:207], v37 offset:2048
    ds_read_b64_tr_b16 v[8:9], v1 offset:0
    ds_read_b64_tr_b16 v[10:11], v1 offset:1024
    ds_read_b64_tr_b16 v[12:13], v1 offset:8192
    ds_read_b64_tr_b16 v[14:15], v1 offset:9216
    ds_read_b64_tr_b16 v[16:17], v2 offset:0
    ds_read_b64_tr_b16 v[18:19], v2 offset:1024
    ds_read_b128 v[208:211], v38 offset:0
    ds_read_b128 v[212:215], v38 offset:2048
    ds_read_b128 v[216:219], v39 offset:0
    ds_read_b128 v[220:223], v39 offset:2048
    s_waitcnt lgkmcnt(8)
    v_mfma_f32_16x16x32_bf16 v[64:67], v[8:11], v[192:195], 0
    s_add_u32 m0, s41, 32768
    ds_read_b64_tr_b16 v[20:21], v2 offset:8192
    ds_read_b64_tr_b16 v[22:23], v2 offset:9216
    v_mfma_f32_16x16x32_bf16 v[68:71], v[8:11], v[196:199], 0
    s_add_u32 s39, s26, s45
    v_mfma_f32_16x16x32_bf16 v[72:75], v[8:11], v[200:203], 0
    buffer_load_dwordx4 v40, s[4:7], s39 offen offset:0 lds
    v_mfma_f32_16x16x32_bf16 v[76:79], v[8:11], v[204:207], 0
    s_add_u32 s39, s39, 9216
    v_mfma_f32_16x16x32_bf16 v[28:31], v[8:11], v[24:27], 0
    buffer_store_dword v24, v135, s[60:63], 0 offen sc1
    v_mfma_f32_16x16x32_bf16 v[176:179], v[24:27], v[192:195], 0
    buffer_load_dwordx4 v41, s[4:7], s39 offen offset:1024 lds
    v_mfma_f32_16x16x32_bf16 v[184:187], v[192:195], v[192:195], 0
    s_waitcnt lgkmcnt(8)
    s_add_u32 s39, s39, 9216
    v_mfma_f32_16x16x32_bf16 v[92:95], v[12:15], v[204:207], 0
    s_lshl_b32 s70, s49, 2
    ds_read_b64_tr_b16 v[8:9], v1 offset:4096
    ds_read_b64_tr_b16 v[10:11], v1 offset:5120
    v_mfma_f32_16x16x32_bf16 v[88:91], v[12:15], v[200:203], 0
    buffer_load_dwordx4 v40, s[4:7], s39 offen offset:2048 lds
    v_mfma_f32_16x16x32_bf16 v[84:87], v[12:15], v[196:199], 0
    s_add_u32 s39, s39, 9216
    s_add_u32 s70, s70, s46
    v_mfma_f32_16x16x32_bf16 v[80:83], v[12:15], v[192:195], 0
    s_mul_i32 s71, s70, 122880
    s_xor_b32 s70, s70, 1
    v_mfma_f32_16x16x32_bf16 v[32:35], v[12:15], v[24:27], 0
    buffer_load_dwordx4 v41, s[4:7], s39 offen offset:3072 lds
    v_mfma_f32_16x16x32_bf16 v[180:183], v[24:27], v[196:199], 0
    s_add_u32 m0, s41, 98304
    s_mul_i32 s39, s26, 1920
    v_mfma_f32_16x16x32_bf16 v[188:191], v[196:199], v[196:199], 0
    s_waitcnt lgkmcnt(8)
    s_add_u32 s39, s39, s42
    v_mfma_f32_16x16x32_bf16 v[96:99], v[16:19], v[192:195], 0
    s_mul_i32 s72, s70, 122880
    ds_read_b64_tr_b16 v[12:13], v1 offset:12288
    ds_read_b64_tr_b16 v[14:15], v1 offset:13312
    v_mfma_f32_16x16x32_bf16 v[100:103], v[16:19], v[196:199], 0
    buffer_load_dwordx4 v5, s[8:11], s39 offen offset:0 lds
    v_mfma_f32_16x16x32_bf16 v[104:107], v[16:19], v[200:203], 0
    s_add_u32 s39, s39, 14336
    s_lshl_b32 s70, s50, 2
    v_mfma_f32_16x16x32_bf16 v[108:111], v[16:19], v[204:207], 0
    s_waitcnt lgkmcnt(9)
    s_add_u32 s70, s70, s48
    s_lshl_b32 s70, s70, 1
    v_mfma_f32_16x16x32_bf16 v[176:179], v[24:27], v[208:211], v[176:179]
    buffer_load_dwordx4 v5, s[8:11], s39 offen offset:1024 lds
    v_mfma_f32_16x16x32_bf16 v[184:187], v[208:211], v[208:211], v[184:187]
    s_waitcnt lgkmcnt(4)
    s_add_u32 s39, s39, 45056
    v_mfma_f32_16x16x32_bf16 v[124:127], v[20:23], v[204:207], 0
    s_add_u32 s70, s70, s47
    ds_read_b64_tr_b16 v[16:17], v2 offset:4096
    ds_read_b64_tr_b16 v[18:19], v2 offset:5120
    v_mfma_f32_16x16x32_bf16 v[120:123], v[20:23], v[200:203], 0
    buffer_load_dwordx4 v5, s[8:11], s39 offen offset:2048 lds
    v_mfma_f32_16x16x32_bf16 v[116:119], v[20:23], v[196:199], 0
    s_add_u32 s39, s39, 14336
    s_lshl_b32 s70, s70, 10
    v_mfma_f32_16x16x32_bf16 v[112:115], v[20:23], v[192:195], 0
    s_add_u32 s52, s71, s70
    s_add_u32 s54, s72, s70
    v_mfma_f32_16x16x32_bf16 v[180:183], v[24:27], v[212:215], v[180:183]
    buffer_load_dwordx4 v5, s[8:11], s39 offen offset:3072 lds
    v_mfma_f32_16x16x32_bf16 v[188:191], v[212:215], v[212:215], v[188:191]
    s_waitcnt lgkmcnt(4)
    s_xor_b32 s70, s70, 1024
    v_mfma_f32_16x16x32_bf16 v[64:67], v[8:11], v[208:211], v[64:67]
    s_add_u32 s53, s71, s70
    ds_read_b64_tr_b16 v[20:21], v2 offset:12288
    ds_read_b64_tr_b16 v[22:23], v2 offset:13312
    v_mfma_f32_16x16x32_bf16 v[68:71], v[8:11], v[212:215], v[68:71]
    s_add_u32 s55, s72, s70
    s_lshl_b32 s70, s49, 1
    v_mfma_f32_16x16x32_bf16 v[72:75], v[8:11], v[216:219], v[72:75]
    s_add_u32 s70, s70, s47
    s_mul_i32 s70, s70, 294912
    v_mfma_f32_16x16x32_bf16 v[76:79], v[8:11], v[220:223], v[76:79]
    s_add_u32 s70, s70, 8388608
    s_lshl_b32 s71, s48, 11
    v_mfma_f32_16x16x32_bf16 v[28:31], v[8:11], v[24:27], v[28:31]
    s_waitcnt vmcnt(9) lgkmcnt(4)
    s_add_u32 s70, s70, s71
    v_mfma_f32_16x16x32_bf16 v[92:95], v[12:15], v[220:223], v[92:95]
    s_barrier
    ds_read_b64_tr_b16 v[8:9], v1 offset:16384
    ds_read_b64_tr_b16 v[10:11], v1 offset:17408
    v_mfma_f32_16x16x32_bf16 v[88:91], v[12:15], v[216:219], v[88:91]
    s_add_u32 m0, s41, 49152
    ds_read_b128 v[224:227], v36 offset:16384
    ds_read_b128 v[228:231], v36 offset:18432
    v_mfma_f32_16x16x32_bf16 v[84:87], v[12:15], v[212:215], v[84:87]
    s_add_u32 s39, s27, s45
    s_lshl_b32 s72, s48, 9
    v_mfma_f32_16x16x32_bf16 v[80:83], v[12:15], v[208:211], v[80:83]
    buffer_load_dwordx4 v40, s[4:7], s39 offen offset:0 lds
    v_mfma_f32_16x16x32_bf16 v[32:35], v[12:15], v[24:27], v[32:35]
    s_waitcnt lgkmcnt(6)
    ds_read_b128 v[232:235], v37 offset:16384
    ds_read_b128 v[236:239], v37 offset:18432
    v_mfma_f32_16x16x32_bf16 v[96:99], v[16:19], v[208:211], v[96:99]
    s_add_u32 s39, s39, 9216
    ds_read_b64_tr_b16 v[12:13], v1 offset:24576
    ds_read_b64_tr_b16 v[14:15], v1 offset:25600
    v_mfma_f32_16x16x32_bf16 v[100:103], v[16:19], v[212:215], v[100:103]
    buffer_load_dwordx4 v41, s[4:7], s39 offen offset:1024 lds
    v_mfma_f32_16x16x32_bf16 v[104:107], v[16:19], v[216:219], v[104:107]
    s_add_u32 s39, s39, 9216
    ds_read_b128 v[240:243], v38 offset:16384
    ds_read_b128 v[244:247], v38 offset:18432
    v_mfma_f32_16x16x32_bf16 v[108:111], v[16:19], v[220:223], v[108:111]
    s_waitcnt lgkmcnt(10)
    s_add_u32 s70, s70, s72
    v_mfma_f32_16x16x32_bf16 v[124:127], v[20:23], v[220:223], v[124:127]
    s_lshl_b32 s71, s50, 1
    ds_read_b64_tr_b16 v[16:17], v2 offset:16384
    ds_read_b64_tr_b16 v[18:19], v2 offset:17408
    v_mfma_f32_16x16x32_bf16 v[120:123], v[20:23], v[216:219], v[120:123]
    s_add_u32 s71, s71, s47
    ds_read_b128 v[248:251], v39 offset:16384
    ds_read_b128 v[252:255], v39 offset:18432
    v_mfma_f32_16x16x32_bf16 v[116:119], v[20:23], v[212:215], v[116:119]
    buffer_load_dwordx4 v40, s[4:7], s39 offen offset:2048 lds
    v_mfma_f32_16x16x32_bf16 v[112:115], v[20:23], v[208:211], v[112:115]
    s_waitcnt lgkmcnt(11)
    s_add_u32 s39, s39, 9216
    v_mfma_f32_16x16x32_bf16 v[64:67], v[8:11], v[224:227], v[64:67]
    s_waitcnt lgkmcnt(10)
    s_lshl_b32 s71, s71, 12
    ds_read_b64_tr_b16 v[20:21], v2 offset:24576
    ds_read_b64_tr_b16 v[22:23], v2 offset:25600
    v_mfma_f32_16x16x32_bf16 v[68:71], v[8:11], v[228:231], v[68:71]
    s_waitcnt lgkmcnt(11)
    buffer_load_dwordx4 v41, s[4:7], s39 offen offset:3072 lds
    v_mfma_f32_16x16x32_bf16 v[72:75], v[8:11], v[232:235], v[72:75]
    s_waitcnt lgkmcnt(10)
    s_add_u32 m0, s41, 114688
    s_mul_i32 s39, s27, 1920
    v_mfma_f32_16x16x32_bf16 v[76:79], v[8:11], v[236:239], v[76:79]
    s_add_u32 s39, s39, s42
    s_add_u32 s56, s70, s71
    v_mfma_f32_16x16x32_bf16 v[28:31], v[8:11], v[24:27], v[28:31]
    buffer_load_dwordx4 v5, s[8:11], s39 offen offset:0 lds
    v_mfma_f32_16x16x32_bf16 v[176:179], v[24:27], v[224:227], v[176:179]
    s_add_u32 s39, s39, 14336
    s_add_u32 s71, s50, 32
    v_mfma_f32_16x16x32_bf16 v[184:187], v[224:227], v[224:227], v[184:187]
    s_waitcnt lgkmcnt(8)
    s_lshl_b32 s71, s71, 12
    v_mfma_f32_16x16x32_bf16 v[92:95], v[12:15], v[236:239], v[92:95]
    s_add_u32 s57, s70, s71
    ds_read_b64_tr_b16 v[8:9], v1 offset:20480
    ds_read_b64_tr_b16 v[10:11], v1 offset:21504
    v_mfma_f32_16x16x32_bf16 v[88:91], v[12:15], v[232:235], v[88:91]
    buffer_load_dwordx4 v5, s[8:11], s39 offen offset:1024 lds
    v_mfma_f32_16x16x32_bf16 v[84:87], v[12:15], v[228:231], v[84:87]
    s_add_u32 s39, s39, 45056
    v_mfma_f32_16x16x32_bf16 v[80:83], v[12:15], v[224:227], v[80:83]
    v_mfma_f32_16x16x32_bf16 v[32:35], v[12:15], v[24:27], v[32:35]
    buffer_load_dwordx4 v5, s[8:11], s39 offen offset:2048 lds
    v_mfma_f32_16x16x32_bf16 v[180:183], v[24:27], v[228:231], v[180:183]
    s_add_u32 s39, s39, 14336
    v_mfma_f32_16x16x32_bf16 v[188:191], v[228:231], v[228:231], v[188:191]
    s_waitcnt lgkmcnt(6)
    v_mfma_f32_16x16x32_bf16 v[96:99], v[16:19], v[224:227], v[96:99]
    ds_read_b64_tr_b16 v[12:13], v1 offset:28672
    ds_read_b64_tr_b16 v[14:15], v1 offset:29696
    v_mfma_f32_16x16x32_bf16 v[100:103], v[16:19], v[228:231], v[100:103]
    buffer_load_dwordx4 v5, s[8:11], s39 offen offset:3072 lds
    v_mfma_f32_16x16x32_bf16 v[104:107], v[16:19], v[232:235], v[104:107]
    s_add_u32 m0, s41, 0
    s_add_u32 s39, s28, s45
    v_mfma_f32_16x16x32_bf16 v[108:111], v[16:19], v[236:239], v[108:111]
    v_mfma_f32_16x16x32_bf16 v[176:179], v[24:27], v[240:243], v[176:179]
    buffer_load_dwordx4 v40, s[4:7], s39 offen offset:0 lds
    v_mfma_f32_16x16x32_bf16 v[184:187], v[240:243], v[240:243], v[184:187]
    s_waitcnt lgkmcnt(4)
    s_add_u32 s39, s39, 9216
    v_mfma_f32_16x16x32_bf16 v[124:127], v[20:23], v[236:239], v[124:127]
    ds_read_b64_tr_b16 v[16:17], v2 offset:20480
    ds_read_b64_tr_b16 v[18:19], v2 offset:21504
    v_mfma_f32_16x16x32_bf16 v[120:123], v[20:23], v[232:235], v[120:123]
    buffer_load_dwordx4 v41, s[4:7], s39 offen offset:1024 lds
    v_mfma_f32_16x16x32_bf16 v[116:119], v[20:23], v[228:231], v[116:119]
    s_add_u32 s39, s39, 9216
    v_mfma_f32_16x16x32_bf16 v[112:115], v[20:23], v[224:227], v[112:115]
    v_mfma_f32_16x16x32_bf16 v[180:183], v[24:27], v[244:247], v[180:183]
    buffer_load_dwordx4 v40, s[4:7], s39 offen offset:2048 lds
    v_mfma_f32_16x16x32_bf16 v[188:191], v[244:247], v[244:247], v[188:191]
    s_waitcnt lgkmcnt(4)
    s_add_u32 s39, s39, 9216
    v_mfma_f32_16x16x32_bf16 v[64:67], v[8:11], v[240:243], v[64:67]
    ds_read_b64_tr_b16 v[20:21], v2 offset:28672
    ds_read_b64_tr_b16 v[22:23], v2 offset:29696
    v_mfma_f32_16x16x32_bf16 v[68:71], v[8:11], v[244:247], v[68:71]
    buffer_load_dwordx4 v41, s[4:7], s39 offen offset:3072 lds
    v_mfma_f32_16x16x32_bf16 v[72:75], v[8:11], v[248:251], v[72:75]
    v_mfma_f32_16x16x32_bf16 v[76:79], v[8:11], v[252:255], v[76:79]
    v_mfma_f32_16x16x32_bf16 v[28:31], v[8:11], v[24:27], v[28:31]
    s_waitcnt vmcnt(12) lgkmcnt(4)
    v_mfma_f32_16x16x32_bf16 v[92:95], v[12:15], v[252:255], v[92:95]
    s_barrier
    ds_read_b64_tr_b16 v[8:9], v1 offset:32768
    ds_read_b64_tr_b16 v[10:11], v1 offset:33792
    v_mfma_f32_16x16x32_bf16 v[88:91], v[12:15], v[248:251], v[88:91]
    s_add_u32 m0, s41, 131072
    ds_read_b128 a[192:195], v36 offset:32768
    ds_read_b128 a[196:199], v36 offset:34816
    v_mfma_f32_16x16x32_bf16 v[84:87], v[12:15], v[244:247], v[84:87]
    s_mul_i32 s39, s28, 1920
    s_add_u32 s39, s39, s42
    v_mfma_f32_16x16x32_bf16 v[80:83], v[12:15], v[240:243], v[80:83]
    buffer_load_dwordx4 v5, s[8:11], s39 offen offset:0 lds
    v_mfma_f32_16x16x32_bf16 v[32:35], v[12:15], v[24:27], v[32:35]
    s_waitcnt lgkmcnt(6)
    ds_read_b128 a[200:203], v37 offset:32768
    ds_read_b128 a[204:207], v37 offset:34816
    v_mfma_f32_16x16x32_bf16 v[96:99], v[16:19], v[240:243], v[96:99]
    s_add_u32 s39, s39, 14336
    ds_read_b64_tr_b16 v[12:13], v1 offset:40960
    ds_read_b64_tr_b16 v[14:15], v1 offset:41984
    v_mfma_f32_16x16x32_bf16 v[100:103], v[16:19], v[244:247], v[100:103]
    buffer_load_dwordx4 v5, s[8:11], s39 offen offset:1024 lds
    v_mfma_f32_16x16x32_bf16 v[104:107], v[16:19], v[248:251], v[104:107]
    s_add_u32 s39, s39, 45056
    ds_read_b128 a[208:211], v38 offset:32768
    ds_read_b128 a[212:215], v38 offset:34816
    v_mfma_f32_16x16x32_bf16 v[108:111], v[16:19], v[252:255], v[108:111]
    s_waitcnt lgkmcnt(10)
    v_mfma_f32_16x16x32_bf16 v[124:127], v[20:23], v[252:255], v[124:127]
    ds_read_b64_tr_b16 v[16:17], v2 offset:32768
    ds_read_b64_tr_b16 v[18:19], v2 offset:33792
    v_mfma_f32_16x16x32_bf16 v[120:123], v[20:23], v[248:251], v[120:123]
    ds_read_b128 a[216:219], v39 offset:32768
    ds_read_b128 a[220:223], v39 offset:34816
    v_mfma_f32_16x16x32_bf16 v[116:119], v[20:23], v[244:247], v[116:119]
    buffer_load_dwordx4 v5, s[8:11], s39 offen offset:2048 lds
    v_mfma_f32_16x16x32_bf16 v[112:115], v[20:23], v[240:243], v[112:115]
    s_waitcnt lgkmcnt(11)
    s_add_u32 s39, s39, 14336
    v_mfma_f32_16x16x32_bf16 v[64:67], v[8:11], a[192:195], v[64:67]
    s_waitcnt lgkmcnt(10)
    ds_read_b64_tr_b16 v[20:21], v2 offset:40960
    ds_read_b64_tr_b16 v[22:23], v2 offset:41984
    v_mfma_f32_16x16x32_bf16 v[68:71], v[8:11], a[196:199], v[68:71]
    s_waitcnt lgkmcnt(11)
    buffer_load_dwordx4 v5, s[8:11], s39 offen offset:3072 lds
    v_mfma_f32_16x16x32_bf16 v[72:75], v[8:11], a[200:203], v[72:75]
    s_waitcnt lgkmcnt(10)
    s_add_u32 m0, s41, 16384
    s_add_u32 s39, s29, s45
    v_mfma_f32_16x16x32_bf16 v[76:79], v[8:11], a[204:207], v[76:79]
    v_mfma_f32_16x16x32_bf16 v[28:31], v[8:11], v[24:27], v[28:31]
    buffer_load_dwordx4 v40, s[4:7], s39 offen offset:0 lds
    v_mfma_f32_16x16x32_bf16 v[176:179], v[24:27], a[192:195], v[176:179]
    s_add_u32 s39, s39, 9216
    v_mfma_f32_16x16x32_bf16 v[184:187], a[192:195], a[192:195], v[184:187]
    s_waitcnt lgkmcnt(8)
    v_mfma_f32_16x16x32_bf16 v[92:95], v[12:15], a[204:207], v[92:95]
    ds_read_b64_tr_b16 v[8:9], v1 offset:36864
    ds_read_b64_tr_b16 v[10:11], v1 offset:37888
    v_mfma_f32_16x16x32_bf16 v[88:91], v[12:15], a[200:203], v[88:91]
    buffer_load_dwordx4 v41, s[4:7], s39 offen offset:1024 lds
    v_mfma_f32_16x16x32_bf16 v[84:87], v[12:15], a[196:199], v[84:87]
    s_add_u32 s39, s39, 9216
    v_mfma_f32_16x16x32_bf16 v[80:83], v[12:15], a[192:195], v[80:83]
    v_mfma_f32_16x16x32_bf16 v[32:35], v[12:15], v[24:27], v[32:35]
    buffer_load_dwordx4 v40, s[4:7], s39 offen offset:2048 lds
    v_mfma_f32_16x16x32_bf16 v[180:183], v[24:27], a[196:199], v[180:183]
    s_add_u32 s39, s39, 9216
    v_mfma_f32_16x16x32_bf16 v[188:191], a[196:199], a[196:199], v[188:191]
    s_waitcnt lgkmcnt(6)
    v_mfma_f32_16x16x32_bf16 v[96:99], v[16:19], a[192:195], v[96:99]
    ds_read_b64_tr_b16 v[12:13], v1 offset:45056
    ds_read_b64_tr_b16 v[14:15], v1 offset:46080
    v_mfma_f32_16x16x32_bf16 v[100:103], v[16:19], a[196:199], v[100:103]
    buffer_load_dwordx4 v41, s[4:7], s39 offen offset:3072 lds
    v_mfma_f32_16x16x32_bf16 v[104:107], v[16:19], a[200:203], v[104:107]
    s_add_u32 m0, s41, 65536
    s_mul_i32 s39, s29, 1920
    v_mfma_f32_16x16x32_bf16 v[108:111], v[16:19], a[204:207], v[108:111]
    s_add_u32 s39, s39, s42
    v_mfma_f32_16x16x32_bf16 v[176:179], v[24:27], a[208:211], v[176:179]
    buffer_load_dwordx4 v5, s[8:11], s39 offen offset:0 lds
    v_mfma_f32_16x16x32_bf16 v[184:187], a[208:211], a[208:211], v[184:187]
    s_waitcnt lgkmcnt(4)
    s_add_u32 s39, s39, 14336
    v_mfma_f32_16x16x32_bf16 v[124:127], v[20:23], a[204:207], v[124:127]
    ds_read_b64_tr_b16 v[16:17], v2 offset:36864
    ds_read_b64_tr_b16 v[18:19], v2 offset:37888
    v_mfma_f32_16x16x32_bf16 v[120:123], v[20:23], a[200:203], v[120:123]
    buffer_load_dwordx4 v5, s[8:11], s39 offen offset:1024 lds
    v_mfma_f32_16x16x32_bf16 v[116:119], v[20:23], a[196:199], v[116:119]
    s_add_u32 s39, s39, 45056
    v_mfma_f32_16x16x32_bf16 v[112:115], v[20:23], a[192:195], v[112:115]
    v_mfma_f32_16x16x32_bf16 v[180:183], v[24:27], a[212:215], v[180:183]
    buffer_load_dwordx4 v5, s[8:11], s39 offen offset:2048 lds
    v_mfma_f32_16x16x32_bf16 v[188:191], a[212:215], a[212:215], v[188:191]
    s_waitcnt lgkmcnt(4)
    s_add_u32 s39, s39, 14336
    v_mfma_f32_16x16x32_bf16 v[64:67], v[8:11], a[208:211], v[64:67]
    ds_read_b64_tr_b16 v[20:21], v2 offset:45056
    ds_read_b64_tr_b16 v[22:23], v2 offset:46080
    v_mfma_f32_16x16x32_bf16 v[68:71], v[8:11], a[212:215], v[68:71]
    buffer_load_dwordx4 v5, s[8:11], s39 offen offset:3072 lds
    v_mfma_f32_16x16x32_bf16 v[72:75], v[8:11], a[216:219], v[72:75]
    v_mfma_f32_16x16x32_bf16 v[76:79], v[8:11], a[220:223], v[76:79]
    v_mfma_f32_16x16x32_bf16 v[28:31], v[8:11], v[24:27], v[28:31]
    s_waitcnt vmcnt(16) lgkmcnt(4)
    v_mfma_f32_16x16x32_bf16 v[92:95], v[12:15], a[220:223], v[92:95]
    s_barrier
    ds_read_b64_tr_b16 v[8:9], v1 offset:49152
    ds_read_b64_tr_b16 v[10:11], v1 offset:50176
    v_mfma_f32_16x16x32_bf16 v[88:91], v[12:15], a[216:219], v[88:91]
    s_add_u32 m0, s41, 32768
    ds_read_b128 a[224:227], v36 offset:49152
    ds_read_b128 a[228:231], v36 offset:51200
    v_mfma_f32_16x16x32_bf16 v[84:87], v[12:15], a[212:215], v[84:87]
    s_add_u32 s39, s30, s45
    v_mfma_f32_16x16x32_bf16 v[80:83], v[12:15], a[208:211], v[80:83]
    buffer_load_dwordx4 v40, s[4:7], s39 offen offset:0 lds
    v_mfma_f32_16x16x32_bf16 v[32:35], v[12:15], v[24:27], v[32:35]
    s_waitcnt lgkmcnt(6)
    ds_read_b128 a[232:235], v37 offset:49152
    ds_read_b128 a[236:239], v37 offset:51200
    v_mfma_f32_16x16x32_bf16 v[96:99], v[16:19], a[208:211], v[96:99]
    s_add_u32 s39, s39, 9216
    ds_read_b64_tr_b16 v[12:13], v1 offset:57344
    ds_read_b64_tr_b16 v[14:15], v1 offset:58368
    v_mfma_f32_16x16x32_bf16 v[100:103], v[16:19], a[212:215], v[100:103]
    buffer_load_dwordx4 v41, s[4:7], s39 offen offset:1024 lds
    v_mfma_f32_16x16x32_bf16 v[104:107], v[16:19], a[216:219], v[104:107]
    s_add_u32 s39, s39, 9216
    ds_read_b128 a[240:243], v38 offset:49152
    ds_read_b128 a[244:247], v38 offset:51200
    v_mfma_f32_16x16x32_bf16 v[108:111], v[16:19], a[220:223], v[108:111]
    s_waitcnt lgkmcnt(10)
    v_mfma_f32_16x16x32_bf16 v[124:127], v[20:23], a[220:223], v[124:127]
    ds_read_b64_tr_b16 v[16:17], v2 offset:49152
    ds_read_b64_tr_b16 v[18:19], v2 offset:50176
    v_mfma_f32_16x16x32_bf16 v[120:123], v[20:23], a[216:219], v[120:123]
    ds_read_b128 a[248:251], v39 offset:49152
    ds_read_b128 a[252:255], v39 offset:51200
    v_mfma_f32_16x16x32_bf16 v[116:119], v[20:23], a[212:215], v[116:119]
    buffer_load_dwordx4 v40, s[4:7], s39 offen offset:2048 lds
    v_mfma_f32_16x16x32_bf16 v[112:115], v[20:23], a[208:211], v[112:115]
    s_waitcnt lgkmcnt(11)
    s_add_u32 s39, s39, 9216
    v_mfma_f32_16x16x32_bf16 v[64:67], v[8:11], a[224:227], v[64:67]
    s_waitcnt lgkmcnt(10)
    ds_read_b64_tr_b16 v[20:21], v2 offset:57344
    ds_read_b64_tr_b16 v[22:23], v2 offset:58368
    v_mfma_f32_16x16x32_bf16 v[68:71], v[8:11], a[228:231], v[68:71]
    s_waitcnt lgkmcnt(11)
    buffer_load_dwordx4 v41, s[4:7], s39 offen offset:3072 lds
    v_mfma_f32_16x16x32_bf16 v[72:75], v[8:11], a[232:235], v[72:75]
    s_waitcnt lgkmcnt(10)
    s_add_u32 m0, s41, 81920
    s_mul_i32 s39, s30, 1920
    v_mfma_f32_16x16x32_bf16 v[76:79], v[8:11], a[236:239], v[76:79]
    s_add_u32 s39, s39, s42
    v_mfma_f32_16x16x32_bf16 v[28:31], v[8:11], v[24:27], v[28:31]
    buffer_load_dwordx4 v5, s[8:11], s39 offen offset:0 lds
    v_mfma_f32_16x16x32_bf16 v[176:179], v[24:27], a[224:227], v[176:179]
    s_add_u32 s39, s39, 14336
    v_mfma_f32_16x16x32_bf16 v[184:187], a[224:227], a[224:227], v[184:187]
    s_waitcnt lgkmcnt(8)
    v_mfma_f32_16x16x32_bf16 v[92:95], v[12:15], a[236:239], v[92:95]
    ds_read_b64_tr_b16 v[8:9], v1 offset:53248
    ds_read_b64_tr_b16 v[10:11], v1 offset:54272
    v_mfma_f32_16x16x32_bf16 v[88:91], v[12:15], a[232:235], v[88:91]
    buffer_load_dwordx4 v5, s[8:11], s39 offen offset:1024 lds
    v_mfma_f32_16x16x32_bf16 v[84:87], v[12:15], a[228:231], v[84:87]
    s_add_u32 s39, s39, 45056
    v_mfma_f32_16x16x32_bf16 v[80:83], v[12:15], a[224:227], v[80:83]
    v_mfma_f32_16x16x32_bf16 v[32:35], v[12:15], v[24:27], v[32:35]
    buffer_load_dwordx4 v5, s[8:11], s39 offen offset:2048 lds
    v_mfma_f32_16x16x32_bf16 v[180:183], v[24:27], a[228:231], v[180:183]
    s_add_u32 s39, s39, 14336
    v_mfma_f32_16x16x32_bf16 v[188:191], a[228:231], a[228:231], v[188:191]
    s_waitcnt lgkmcnt(6)
    v_mfma_f32_16x16x32_bf16 v[96:99], v[16:19], a[224:227], v[96:99]
    ds_read_b64_tr_b16 v[12:13], v1 offset:61440
    ds_read_b64_tr_b16 v[14:15], v1 offset:62464
    v_mfma_f32_16x16x32_bf16 v[100:103], v[16:19], a[228:231], v[100:103]
    buffer_load_dwordx4 v5, s[8:11], s39 offen offset:3072 lds
    v_mfma_f32_16x16x32_bf16 v[104:107], v[16:19], a[232:235], v[104:107]
    s_add_u32 m0, s41, 147456
    v_mfma_f32_16x16x32_bf16 v[108:111], v[16:19], a[236:239], v[108:111]
    v_mfma_f32_16x16x32_bf16 v[176:179], v[24:27], a[240:243], v[176:179]
    buffer_load_dwordx4 v128, s[64:67], s80 offen offset:0 nt lds
    v_mfma_f32_16x16x32_bf16 v[184:187], a[240:243], a[240:243], v[184:187]
    s_waitcnt lgkmcnt(4)
    s_add_u32 s80, s80, s81
    v_mfma_f32_16x16x32_bf16 v[124:127], v[20:23], a[236:239], v[124:127]
    ds_read_b64_tr_b16 v[16:17], v2 offset:53248
    ds_read_b64_tr_b16 v[18:19], v2 offset:54272
    v_mfma_f32_16x16x32_bf16 v[120:123], v[20:23], a[232:235], v[120:123]
    buffer_load_dwordx4 v128, s[64:67], s80 offen offset:1024 nt lds
    v_mfma_f32_16x16x32_bf16 v[116:119], v[20:23], a[228:231], v[116:119]
    s_add_u32 s80, s80, s0
    v_mfma_f32_16x16x32_bf16 v[112:115], v[20:23], a[224:227], v[112:115]
    v_mfma_f32_16x16x32_bf16 v[180:183], v[24:27], a[244:247], v[180:183]
    buffer_load_dwordx4 v128, s[64:67], s80 offen offset:2048 nt lds
    v_mfma_f32_16x16x32_bf16 v[188:191], a[244:247], a[244:247], v[188:191]
    s_waitcnt lgkmcnt(4)
    s_add_u32 s80, s80, s81
    v_mfma_f32_16x16x32_bf16 v[64:67], v[8:11], a[240:243], v[64:67]
    ds_read_b64_tr_b16 v[20:21], v2 offset:61440
    ds_read_b64_tr_b16 v[22:23], v2 offset:62464
    v_mfma_f32_16x16x32_bf16 v[68:71], v[8:11], a[244:247], v[68:71]
    buffer_load_dwordx4 v128, s[64:67], s80 offen offset:3072 nt lds
    v_mfma_f32_16x16x32_bf16 v[72:75], v[8:11], a[248:251], v[72:75]
    v_mfma_f32_16x16x32_bf16 v[76:79], v[8:11], a[252:255], v[76:79]
    v_mfma_f32_16x16x32_bf16 v[28:31], v[8:11], v[24:27], v[28:31]
    s_waitcnt vmcnt(20) lgkmcnt(4)
    v_add_u32 v1, 65536, v1
    v_mfma_f32_16x16x32_bf16 v[92:95], v[12:15], a[252:255], v[92:95]
    s_barrier
    ds_read_b64_tr_b16 v[8:9], v1 offset:0
    ds_read_b64_tr_b16 v[10:11], v1 offset:1024
    v_mfma_f32_16x16x32_bf16 v[88:91], v[12:15], a[248:251], v[88:91]
    s_add_u32 m0, s41, 49152
    ds_read_b128 a[0:3], v36 offset:0
    ds_read_b128 a[4:7], v36 offset:2048
    v_mfma_f32_16x16x32_bf16 v[84:87], v[12:15], a[244:247], v[84:87]
    s_add_u32 s39, s31, s45
    v_mfma_f32_16x16x32_bf16 v[80:83], v[12:15], a[240:243], v[80:83]
    buffer_load_dwordx4 v40, s[4:7], s39 offen offset:0 lds
    v_mfma_f32_16x16x32_bf16 v[32:35], v[12:15], v[24:27], v[32:35]
    s_waitcnt lgkmcnt(6)
    ds_read_b128 a[8:11], v37 offset:0
    ds_read_b128 a[12:15], v37 offset:2048
    v_mfma_f32_16x16x32_bf16 v[96:99], v[16:19], a[240:243], v[96:99]
    s_add_u32 s39, s39, 9216
    ds_read_b64_tr_b16 v[12:13], v1 offset:8192
    ds_read_b64_tr_b16 v[14:15], v1 offset:9216
    v_mfma_f32_16x16x32_bf16 v[100:103], v[16:19], a[244:247], v[100:103]
    v_mfma_f32_16x16x32_bf16 v[104:107], v[16:19], a[248:251], v[104:107]
    ds_read_b128 a[16:19], v38 offset:0
    ds_read_b128 a[20:23], v38 offset:2048
    v_mfma_f32_16x16x32_bf16 v[108:111], v[16:19], a[252:255], v[108:111]
    s_waitcnt lgkmcnt(10)
    v_add_u32 v2, 65536, v2
    v_mfma_f32_16x16x32_bf16 v[124:127], v[20:23], a[252:255], v[124:127]
    ds_read_b64_tr_b16 v[16:17], v2 offset:0
    ds_read_b64_tr_b16 v[18:19], v2 offset:1024
    v_mfma_f32_16x16x32_bf16 v[120:123], v[20:23], a[248:251], v[120:123]
    ds_read_b128 a[24:27], v39 offset:0
    ds_read_b128 a[28:31], v39 offset:2048
    v_mfma_f32_16x16x32_bf16 v[116:119], v[20:23], a[244:247], v[116:119]
    buffer_load_dwordx4 v41, s[4:7], s39 offen offset:1024 lds
    v_mfma_f32_16x16x32_bf16 v[112:115], v[20:23], a[240:243], v[112:115]
    s_waitcnt lgkmcnt(11)
    s_add_u32 s39, s39, 9216
    v_mfma_f32_16x16x32_bf16 v[64:67], v[8:11], a[0:3], v[64:67]
    s_waitcnt lgkmcnt(10)
    ds_read_b64_tr_b16 v[20:21], v2 offset:8192
    ds_read_b64_tr_b16 v[22:23], v2 offset:9216
    v_mfma_f32_16x16x32_bf16 v[68:71], v[8:11], a[4:7], v[68:71]
    s_waitcnt lgkmcnt(11)
    v_mfma_f32_16x16x32_bf16 v[72:75], v[8:11], a[8:11], v[72:75]
    s_waitcnt lgkmcnt(10)
    v_mfma_f32_16x16x32_bf16 v[76:79], v[8:11], a[12:15], v[76:79]
    buffer_load_dwordx4 v40, s[4:7], s39 offen offset:2048 lds
    v_mfma_f32_16x16x32_bf16 v[28:31], v[8:11], v[24:27], v[28:31]
    s_add_u32 s39, s39, 9216
    v_mfma_f32_16x16x32_bf16 v[176:179], v[24:27], a[0:3], v[176:179]
    v_mfma_f32_16x16x32_bf16 v[184:187], a[0:3], a[0:3], v[184:187]
    s_waitcnt lgkmcnt(8)
    v_mfma_f32_16x16x32_bf16 v[92:95], v[12:15], a[12:15], v[92:95]
    ds_read_b64_tr_b16 v[8:9], v1 offset:4096
    ds_read_b64_tr_b16 v[10:11], v1 offset:5120
    v_mfma_f32_16x16x32_bf16 v[88:91], v[12:15], a[8:11], v[88:91]
    buffer_load_dwordx4 v41, s[4:7], s39 offen offset:3072 lds
    v_mfma_f32_16x16x32_bf16 v[84:87], v[12:15], a[4:7], v[84:87]
    s_add_u32 m0, s41, 98304
    s_mul_i32 s39, s31, 1920
    v_mfma_f32_16x16x32_bf16 v[80:83], v[12:15], a[0:3], v[80:83]
    s_add_u32 s39, s39, s42
    v_mfma_f32_16x16x32_bf16 v[32:35], v[12:15], v[24:27], v[32:35]
    v_mfma_f32_16x16x32_bf16 v[180:183], v[24:27], a[4:7], v[180:183]
    v_mfma_f32_16x16x32_bf16 v[188:191], a[4:7], a[4:7], v[188:191]
    s_waitcnt lgkmcnt(6)
    buffer_load_dwordx4 v5, s[8:11], s39 offen offset:0 lds
    v_mfma_f32_16x16x32_bf16 v[96:99], v[16:19], a[0:3], v[96:99]
    s_add_u32 s39, s39, 14336
    ds_read_b64_tr_b16 v[12:13], v1 offset:12288
    ds_read_b64_tr_b16 v[14:15], v1 offset:13312
    v_mfma_f32_16x16x32_bf16 v[100:103], v[16:19], a[4:7], v[100:103]
    v_mfma_f32_16x16x32_bf16 v[104:107], v[16:19], a[8:11], v[104:107]
    v_mfma_f32_16x16x32_bf16 v[108:111], v[16:19], a[12:15], v[108:111]
    v_mfma_f32_16x16x32_bf16 v[176:179], v[24:27], a[16:19], v[176:179]
    buffer_load_dwordx4 v5, s[8:11], s39 offen offset:1024 lds
    v_mfma_f32_16x16x32_bf16 v[184:187], a[16:19], a[16:19], v[184:187]
    s_waitcnt lgkmcnt(4)
    s_add_u32 s39, s39, 45056
    v_mfma_f32_16x16x32_bf16 v[124:127], v[20:23], a[12:15], v[124:127]
    ds_read_b64_tr_b16 v[16:17], v2 offset:4096
    ds_read_b64_tr_b16 v[18:19], v2 offset:5120
    v_mfma_f32_16x16x32_bf16 v[120:123], v[20:23], a[8:11], v[120:123]
    v_mfma_f32_16x16x32_bf16 v[116:119], v[20:23], a[4:7], v[116:119]
    v_mfma_f32_16x16x32_bf16 v[112:115], v[20:23], a[0:3], v[112:115]
    buffer_load_dwordx4 v5, s[8:11], s39 offen offset:2048 lds
    v_mfma_f32_16x16x32_bf16 v[180:183], v[24:27], a[20:23], v[180:183]
    s_add_u32 s39, s39, 14336
    v_mfma_f32_16x16x32_bf16 v[188:191], a[20:23], a[20:23], v[188:191]
    s_waitcnt lgkmcnt(4)
    v_mfma_f32_16x16x32_bf16 v[64:67], v[8:11], a[16:19], v[64:67]
    ds_read_b64_tr_b16 v[20:21], v2 offset:12288
    ds_read_b64_tr_b16 v[22:23], v2 offset:13312
    v_mfma_f32_16x16x32_bf16 v[68:71], v[8:11], a[20:23], v[68:71]
    v_mfma_f32_16x16x32_bf16 v[72:75], v[8:11], a[24:27], v[72:75]
    buffer_load_dwordx4 v5, s[8:11], s39 offen offset:3072 lds
    v_mfma_f32_16x16x32_bf16 v[76:79], v[8:11], a[28:31], v[76:79]
    v_mfma_f32_16x16x32_bf16 v[28:31], v[8:11], v[24:27], v[28:31]
    s_waitcnt vmcnt(20) lgkmcnt(4)
    v_add_u32 v1, 4294901760, v1
    v_mfma_f32_16x16x32_bf16 v[92:95], v[12:15], a[28:31], v[92:95]
    s_barrier
    ds_read_b64_tr_b16 v[8:9], v1 offset:0
    ds_read_b64_tr_b16 v[10:11], v1 offset:1024
    v_mfma_f32_16x16x32_bf16 v[88:91], v[12:15], a[24:27], v[88:91]
    s_add_u32 m0, s41, 0
    ds_read_b128 a[32:35], v36 offset:16384
    ds_read_b128 a[36:39], v36 offset:18432
    v_mfma_f32_16x16x32_bf16 v[84:87], v[12:15], a[20:23], v[84:87]
    s_add_u32 s39, s32, s45
    v_mfma_f32_16x16x32_bf16 v[80:83], v[12:15], a[16:19], v[80:83]
    buffer_load_dwordx4 v40, s[4:7], s39 offen offset:0 lds
    v_mfma_f32_16x16x32_bf16 v[32:35], v[12:15], v[24:27], v[32:35]
    s_waitcnt lgkmcnt(6)
    ds_read_b128 a[40:43], v37 offset:16384
    ds_read_b128 a[44:47], v37 offset:18432
    v_mfma_f32_16x16x32_bf16 v[96:99], v[16:19], a[16:19], v[96:99]
    s_add_u32 s39, s39, 9216
    ds_read_b64_tr_b16 v[12:13], v1 offset:8192
    ds_read_b64_tr_b16 v[14:15], v1 offset:9216
    v_mfma_f32_16x16x32_bf16 v[100:103], v[16:19], a[20:23], v[100:103]
    v_mfma_f32_16x16x32_bf16 v[104:107], v[16:19], a[24:27], v[104:107]
    ds_read_b128 a[48:51], v38 offset:16384
    ds_read_b128 a[52:55], v38 offset:18432
    v_mfma_f32_16x16x32_bf16 v[108:111], v[16:19], a[28:31], v[108:111]
    s_waitcnt lgkmcnt(10)
    v_add_u32 v2, 4294901760, v2
    v_mfma_f32_16x16x32_bf16 v[124:127], v[20:23], a[28:31], v[124:127]
    ds_read_b64_tr_b16 v[16:17], v2 offset:0
    ds_read_b64_tr_b16 v[18:19], v2 offset:1024
    v_mfma_f32_16x16x32_bf16 v[120:123], v[20:23], a[24:27], v[120:123]
    ds_read_b128 a[56:59], v39 offset:16384
    ds_read_b128 a[60:63], v39 offset:18432
    v_mfma_f32_16x16x32_bf16 v[116:119], v[20:23], a[20:23], v[116:119]
    buffer_load_dwordx4 v41, s[4:7], s39 offen offset:1024 lds
    v_mfma_f32_16x16x32_bf16 v[112:115], v[20:23], a[16:19], v[112:115]
    s_waitcnt lgkmcnt(11)
    s_add_u32 s39, s39, 9216
    v_mfma_f32_16x16x32_bf16 v[64:67], v[8:11], a[32:35], v[64:67]
    s_waitcnt lgkmcnt(10)
    ds_read_b64_tr_b16 v[20:21], v2 offset:8192
    ds_read_b64_tr_b16 v[22:23], v2 offset:9216
    v_mfma_f32_16x16x32_bf16 v[68:71], v[8:11], a[36:39], v[68:71]
    s_waitcnt lgkmcnt(11)
    v_mfma_f32_16x16x32_bf16 v[72:75], v[8:11], a[40:43], v[72:75]
    s_waitcnt lgkmcnt(10)
    v_mfma_f32_16x16x32_bf16 v[76:79], v[8:11], a[44:47], v[76:79]
    buffer_load_dwordx4 v40, s[4:7], s39 offen offset:2048 lds
    v_mfma_f32_16x16x32_bf16 v[28:31], v[8:11], v[24:27], v[28:31]
    s_add_u32 s39, s39, 9216
    v_mfma_f32_16x16x32_bf16 v[176:179], v[24:27], a[32:35], v[176:179]
    v_mfma_f32_16x16x32_bf16 v[184:187], a[32:35], a[32:35], v[184:187]
    s_waitcnt lgkmcnt(8)
    v_mfma_f32_16x16x32_bf16 v[92:95], v[12:15], a[44:47], v[92:95]
    ds_read_b64_tr_b16 v[8:9], v1 offset:4096
    ds_read_b64_tr_b16 v[10:11], v1 offset:5120
    v_mfma_f32_16x16x32_bf16 v[88:91], v[12:15], a[40:43], v[88:91]
    buffer_load_dwordx4 v41, s[4:7], s39 offen offset:3072 lds
    v_mfma_f32_16x16x32_bf16 v[84:87], v[12:15], a[36:39], v[84:87]
    s_add_u32 m0, s41, 114688
    s_mul_i32 s39, s32, 1920
    v_mfma_f32_16x16x32_bf16 v[80:83], v[12:15], a[32:35], v[80:83]
    s_add_u32 s39, s39, s42
    v_mfma_f32_16x16x32_bf16 v[32:35], v[12:15], v[24:27], v[32:35]
    v_mfma_f32_16x16x32_bf16 v[180:183], v[24:27], a[36:39], v[180:183]
    v_mfma_f32_16x16x32_bf16 v[188:191], a[36:39], a[36:39], v[188:191]
    s_waitcnt lgkmcnt(6)
    buffer_load_dwordx4 v5, s[8:11], s39 offen offset:0 lds
    v_mfma_f32_16x16x32_bf16 v[96:99], v[16:19], a[32:35], v[96:99]
    s_add_u32 s39, s39, 14336
    ds_read_b64_tr_b16 v[12:13], v1 offset:12288
    ds_read_b64_tr_b16 v[14:15], v1 offset:13312
    v_mfma_f32_16x16x32_bf16 v[100:103], v[16:19], a[36:39], v[100:103]
    s_waitcnt vmcnt(13)
    ds_read_b64_tr_b16 v[144:145], v129 offset:0
    v_mfma_f32_16x16x32_bf16 v[104:107], v[16:19], a[40:43], v[104:107]
    ds_read_b64_tr_b16 v[146:147], v129 offset:1024
    v_mfma_f32_16x16x32_bf16 v[108:111], v[16:19], a[44:47], v[108:111]
    ds_read_b64_tr_b16 v[148:149], v130 offset:0
    v_mfma_f32_16x16x32_bf16 v[176:179], v[24:27], a[48:51], v[176:179]
    buffer_load_dwordx4 v5, s[8:11], s39 offen offset:1024 lds
    v_mfma_f32_16x16x32_bf16 v[184:187], a[48:51], a[48:51], v[184:187]
    s_waitcnt lgkmcnt(7)
    s_add_u32 s39, s39, 45056
    ds_read_b64_tr_b16 v[150:151], v130 offset:1024
    v_mfma_f32_16x16x32_bf16 v[124:127], v[20:23], a[44:47], v[124:127]
    ds_read_b64_tr_b16 v[16:17], v2 offset:4096
    ds_read_b64_tr_b16 v[18:19], v2 offset:5120
    v_mfma_f32_16x16x32_bf16 v[120:123], v[20:23], a[40:43], v[120:123]
    ds_read_b64_tr_b16 v[152:153], v131 offset:0
    v_mfma_f32_16x16x32_bf16 v[116:119], v[20:23], a[36:39], v[116:119]
    ds_read_b64_tr_b16 v[154:155], v131 offset:1024
    v_mfma_f32_16x16x32_bf16 v[112:115], v[20:23], a[32:35], v[112:115]
    buffer_load_dwordx4 v5, s[8:11], s39 offen offset:2048 lds
    v_mfma_f32_16x16x32_bf16 v[180:183], v[24:27], a[52:55], v[180:183]
    s_add_u32 s39, s39, 14336
    ds_read_b64_tr_b16 v[156:157], v132 offset:0
    v_mfma_f32_16x16x32_bf16 v[188:191], a[52:55], a[52:55], v[188:191]
    s_waitcnt lgkmcnt(11)
    ds_read_b64_tr_b16 v[158:159], v132 offset:1024
    v_mfma_f32_16x16x32_bf16 v[64:67], v[8:11], a[48:51], v[64:67]
    ds_read_b64_tr_b16 v[20:21], v2 offset:12288
    ds_read_b64_tr_b16 v[22:23], v2 offset:13312
    v_mfma_f32_16x16x32_bf16 v[68:71], v[8:11], a[52:55], v[68:71]
    v_mfma_f32_16x16x32_bf16 v[72:75], v[8:11], a[56:59], v[72:75]
    buffer_load_dwordx4 v5, s[8:11], s39 offen offset:3072 lds
    v_mfma_f32_16x16x32_bf16 v[76:79], v[8:11], a[60:63], v[76:79]
    v_mfma_f32_16x16x32_bf16 v[28:31], v[8:11], v[24:27], v[28:31]
    s_waitcnt lgkmcnt(12)
    v_mfma_f32_16x16x32_bf16 v[92:95], v[12:15], a[60:63], v[92:95]
    s_barrier
    ds_read_b64_tr_b16 v[8:9], v1 offset:16384
    ds_read_b64_tr_b16 v[10:11], v1 offset:17408
    v_mfma_f32_16x16x32_bf16 v[88:91], v[12:15], a[56:59], v[88:91]
    s_add_u32 m0, s41, 16384
    ds_read_b128 a[64:67], v36 offset:32768
    ds_read_b128 a[68:71], v36 offset:34816
    v_mfma_f32_16x16x32_bf16 v[84:87], v[12:15], a[52:55], v[84:87]
    s_add_u32 s39, s33, s45
    v_mfma_f32_16x16x32_bf16 v[80:83], v[12:15], a[48:51], v[80:83]
    buffer_load_dwordx4 v40, s[4:7], s39 offen offset:0 lds
    v_mfma_f32_16x16x32_bf16 v[32:35], v[12:15], v[24:27], v[32:35]
    s_waitcnt lgkmcnt(10)
    ds_read_b128 a[72:75], v37 offset:32768
    ds_read_b128 a[76:79], v37 offset:34816
    v_mfma_f32_16x16x32_bf16 v[96:99], v[16:19], a[48:51], v[96:99]
    s_add_u32 s39, s39, 9216
    ds_read_b64_tr_b16 v[12:13], v1 offset:24576
    ds_read_b64_tr_b16 v[14:15], v1 offset:25600
    v_mfma_f32_16x16x32_bf16 v[100:103], v[16:19], a[52:55], v[100:103]
    buffer_store_dwordx4 v[144:147], v133, s[16:19], s1 offen offset:0 sc1
    v_mfma_f32_16x16x32_bf16 v[104:107], v[16:19], a[56:59], v[104:107]
    ds_read_b128 a[80:83], v38 offset:32768
    ds_read_b128 a[84:87], v38 offset:34816
    v_mfma_f32_16x16x32_bf16 v[108:111], v[16:19], a[60:63], v[108:111]
    s_waitcnt lgkmcnt(10)
    buffer_load_dwordx4 v41, s[4:7], s39 offen offset:1024 lds
    v_mfma_f32_16x16x32_bf16 v[124:127], v[20:23], a[60:63], v[124:127]
    s_add_u32 s39, s39, 9216
    ds_read_b64_tr_b16 v[16:17], v2 offset:16384
    ds_read_b64_tr_b16 v[18:19], v2 offset:17408
    v_mfma_f32_16x16x32_bf16 v[120:123], v[20:23], a[56:59], v[120:123]
    ds_read_b128 a[88:91], v39 offset:32768
    ds_read_b128 a[92:95], v39 offset:34816
    v_mfma_f32_16x16x32_bf16 v[116:119], v[20:23], a[52:55], v[116:119]
    buffer_store_dwordx4 v[148:151], v133, s[16:19], s1 offen offset:1024 sc1
    v_mfma_f32_16x16x32_bf16 v[112:115], v[20:23], a[48:51], v[112:115]
    s_waitcnt lgkmcnt(11)
    buffer_load_dword v140, v138, s[60:63], 0 offen sc1
    v_mfma_f32_16x16x32_bf16 v[64:67], v[8:11], a[64:67], v[64:67]
    s_waitcnt lgkmcnt(10)
    ds_read_b64_tr_b16 v[20:21], v2 offset:24576
    ds_read_b64_tr_b16 v[22:23], v2 offset:25600
    v_mfma_f32_16x16x32_bf16 v[68:71], v[8:11], a[68:71], v[68:71]
    s_waitcnt lgkmcnt(11)
    buffer_load_dwordx4 v40, s[4:7], s39 offen offset:2048 lds
    v_mfma_f32_16x16x32_bf16 v[72:75], v[8:11], a[72:75], v[72:75]
    s_waitcnt lgkmcnt(10)
    s_add_u32 s39, s39, 9216
    v_mfma_f32_16x16x32_bf16 v[76:79], v[8:11], a[76:79], v[76:79]
    buffer_store_dwordx4 v[152:155], v133, s[16:19], s1 offen offset:2048 sc1
    v_mfma_f32_16x16x32_bf16 v[28:31], v[8:11], v[24:27], v[28:31]
    v_mfma_f32_16x16x32_bf16 v[176:179], v[24:27], a[64:67], v[176:179]
    v_mfma_f32_16x16x32_bf16 v[184:187], a[64:67], a[64:67], v[184:187]
    s_waitcnt lgkmcnt(8)
    buffer_load_dwordx4 v41, s[4:7], s39 offen offset:3072 lds
    v_mfma_f32_16x16x32_bf16 v[92:95], v[12:15], a[76:79], v[92:95]
    s_add_u32 m0, s41, 131072
    ds_read_b64_tr_b16 v[8:9], v1 offset:20480
    ds_read_b64_tr_b16 v[10:11], v1 offset:21504
    v_mfma_f32_16x16x32_bf16 v[88:91], v[12:15], a[72:75], v[88:91]
    s_mul_i32 s39, s33, 1920
    s_add_u32 s39, s39, s42
    v_mfma_f32_16x16x32_bf16 v[84:87], v[12:15], a[68:71], v[84:87]
    buffer_store_dwordx4 v[156:159], v133, s[16:19], s1 offen offset:3072 sc1
    v_mfma_f32_16x16x32_bf16 v[80:83], v[12:15], a[64:67], v[80:83]
    v_mfma_f32_16x16x32_bf16 v[32:35], v[12:15], v[24:27], v[32:35]
    buffer_load_dwordx4 v5, s[8:11], s39 offen offset:0 lds
    v_mfma_f32_16x16x32_bf16 v[180:183], v[24:27], a[68:71], v[180:183]
    s_add_u32 s39, s39, 14336
    v_mfma_f32_16x16x32_bf16 v[188:191], a[68:71], a[68:71], v[188:191]
    s_waitcnt lgkmcnt(6)
    v_mfma_f32_16x16x32_bf16 v[96:99], v[16:19], a[64:67], v[96:99]
    ds_read_b64_tr_b16 v[12:13], v1 offset:28672
    ds_read_b64_tr_b16 v[14:15], v1 offset:29696
    v_mfma_f32_16x16x32_bf16 v[100:103], v[16:19], a[68:71], v[100:103]
    v_mfma_f32_16x16x32_bf16 v[104:107], v[16:19], a[72:75], v[104:107]
    buffer_load_dwordx4 v5, s[8:11], s39 offen offset:1024 lds
    v_mfma_f32_16x16x32_bf16 v[108:111], v[16:19], a[76:79], v[108:111]
    s_add_u32 s39, s39, 45056
    v_mfma_f32_16x16x32_bf16 v[176:179], v[24:27], a[80:83], v[176:179]
    v_mfma_f32_16x16x32_bf16 v[184:187], a[80:83], a[80:83], v[184:187]
    s_waitcnt lgkmcnt(4)
    v_mfma_f32_16x16x32_bf16 v[124:127], v[20:23], a[76:79], v[124:127]
    ds_read_b64_tr_b16 v[16:17], v2 offset:20480
    ds_read_b64_tr_b16 v[18:19], v2 offset:21504
    v_mfma_f32_16x16x32_bf16 v[120:123], v[20:23], a[72:75], v[120:123]
    buffer_load_dwordx4 v5, s[8:11], s39 offen offset:2048 lds
    v_mfma_f32_16x16x32_bf16 v[116:119], v[20:23], a[68:71], v[116:119]
    s_add_u32 s39, s39, 14336
    v_mfma_f32_16x16x32_bf16 v[112:115], v[20:23], a[64:67], v[112:115]
    v_mfma_f32_16x16x32_bf16 v[180:183], v[24:27], a[84:87], v[180:183]
    v_mfma_f32_16x16x32_bf16 v[188:191], a[84:87], a[84:87], v[188:191]
    s_waitcnt lgkmcnt(4)
    v_mfma_f32_16x16x32_bf16 v[64:67], v[8:11], a[80:83], v[64:67]
    ds_read_b64_tr_b16 v[20:21], v2 offset:28672
    ds_read_b64_tr_b16 v[22:23], v2 offset:29696
    v_mfma_f32_16x16x32_bf16 v[68:71], v[8:11], a[84:87], v[68:71]
    buffer_load_dwordx4 v5, s[8:11], s39 offen offset:3072 lds
    v_mfma_f32_16x16x32_bf16 v[72:75], v[8:11], a[88:91], v[72:75]
    s_mov_b32 s8, s76
    s_mov_b32 s9, s77
    v_mov_b32 v5, v134
    v_mfma_f32_16x16x32_bf16 v[76:79], v[8:11], a[92:95], v[76:79]
    s_mov_b32 s10, 2621440
    s_and_b32 s42, s49, 8
    v_mfma_f32_16x16x32_bf16 v[28:31], v[8:11], v[24:27], v[28:31]
    s_waitcnt vmcnt(21) lgkmcnt(4)
    s_add_u32 s0, s49, s42
    v_mfma_f32_16x16x32_bf16 v[92:95], v[12:15], a[92:95], v[92:95]
    s_barrier
    ds_read_b64_tr_b16 v[8:9], v1 offset:32768
    ds_read_b64_tr_b16 v[10:11], v1 offset:33792
    v_mfma_f32_16x16x32_bf16 v[88:91], v[12:15], a[88:91], v[88:91]
    s_add_u32 m0, s41, 32768
    ds_read_b128 a[96:99], v36 offset:49152
    ds_read_b128 a[100:103], v36 offset:51200
    v_mfma_f32_16x16x32_bf16 v[84:87], v[12:15], a[84:87], v[84:87]
    s_mul_i32 s39, s24, 1536
    s_add_u32 s39, s39, s43
    v_mfma_f32_16x16x32_bf16 v[80:83], v[12:15], a[80:83], v[80:83]
    buffer_load_dwordx4 v60, s[12:15], s39 offen offset:0 lds
    v_mfma_f32_16x16x32_bf16 v[32:35], v[12:15], v[24:27], v[32:35]
    s_waitcnt lgkmcnt(6)
    ds_read_b128 a[104:107], v37 offset:49152
    ds_read_b128 a[108:111], v37 offset:51200
    v_mfma_f32_16x16x32_bf16 v[96:99], v[16:19], a[80:83], v[96:99]
    s_addk_i32 s39, 11264
    ds_read_b64_tr_b16 v[12:13], v1 offset:40960
    ds_read_b64_tr_b16 v[14:15], v1 offset:41984
    v_mfma_f32_16x16x32_bf16 v[100:103], v[16:19], a[84:87], v[100:103]
    s_and_b32 s42, s50, 4
    s_lshl_b32 s42, s42, 1
    v_mfma_f32_16x16x32_bf16 v[104:107], v[16:19], a[88:91], v[104:107]
    s_add_u32 s0, s0, s42
    ds_read_b128 a[112:115], v38 offset:49152
    ds_read_b128 a[116:119], v38 offset:51200
    v_mfma_f32_16x16x32_bf16 v[108:111], v[16:19], a[92:95], v[108:111]
    s_waitcnt lgkmcnt(10)
    s_lshr_b32 s42, s50, 3
    v_mfma_f32_16x16x32_bf16 v[124:127], v[20:23], a[92:95], v[124:127]
    s_lshl_b32 s42, s42, 2
    ds_read_b64_tr_b16 v[16:17], v2 offset:32768
    ds_read_b64_tr_b16 v[18:19], v2 offset:33792
    v_mfma_f32_16x16x32_bf16 v[120:123], v[20:23], a[88:91], v[120:123]
    s_and_b32 s3, s50, 3
    ds_read_b128 a[120:123], v39 offset:49152
    ds_read_b128 a[124:127], v39 offset:51200
    v_mfma_f32_16x16x32_bf16 v[116:119], v[20:23], a[84:87], v[116:119]
    buffer_load_dwordx4 v60, s[12:15], s39 offen offset:1024 lds
    v_mfma_f32_16x16x32_bf16 v[112:115], v[20:23], a[80:83], v[112:115]
    s_waitcnt lgkmcnt(11)
    s_add_u32 s39, s39, 35840
    v_mfma_f32_16x16x32_bf16 v[64:67], v[8:11], a[96:99], v[64:67]
    s_waitcnt lgkmcnt(10)
    s_add_u32 s3, s3, s42
    ds_read_b64_tr_b16 v[20:21], v2 offset:40960
    ds_read_b64_tr_b16 v[22:23], v2 offset:41984
    v_mfma_f32_16x16x32_bf16 v[68:71], v[8:11], a[100:103], v[68:71]
    s_waitcnt lgkmcnt(11)
    s_and_b32 s42, s0, 1
    s_lshr_b32 s45, s0, 1
    v_mfma_f32_16x16x32_bf16 v[72:75], v[8:11], a[104:107], v[72:75]
    s_waitcnt lgkmcnt(10)
    s_lshl_b32 s45, s45, 12
    s_add_u32 s45, s45, 22020096
    v_mfma_f32_16x16x32_bf16 v[76:79], v[8:11], a[108:111], v[76:79]
    s_lshl_b32 s80, s42, 10
    s_add_u32 s72, s45, s80
    v_mfma_f32_16x16x32_bf16 v[28:31], v[8:11], v[24:27], v[28:31]
    buffer_load_dwordx4 v60, s[12:15], s39 offen offset:2048 lds
    v_mfma_f32_16x16x32_bf16 v[176:179], v[24:27], a[96:99], v[176:179]
    s_addk_i32 s39, 11264
    s_add_u32 s72, s72, 327680
    v_mfma_f32_16x16x32_bf16 v[184:187], a[96:99], a[96:99], v[184:187]
    s_waitcnt lgkmcnt(8)
    s_lshl_b32 s80, s3, 7
    v_mfma_f32_16x16x32_bf16 v[92:95], v[12:15], a[108:111], v[92:95]
    s_add_u32 s80, s80, s46
    ds_read_b64_tr_b16 v[8:9], v1 offset:36864
    ds_read_b64_tr_b16 v[10:11], v1 offset:37888
    v_mfma_f32_16x16x32_bf16 v[88:91], v[12:15], a[104:107], v[88:91]
    s_add_u32 s1, s72, s80
    s_lshl_b32 s80, s42, 3
    v_mfma_f32_16x16x32_bf16 v[84:87], v[12:15], a[100:103], v[84:87]
    s_add_u32 s45, s45, s80
    s_lshl_b32 s80, s46, 9
    v_mfma_f32_16x16x32_bf16 v[80:83], v[12:15], a[96:99], v[80:83]
    buffer_load_dwordx4 v60, s[12:15], s39 offen offset:3072 lds
    v_mfma_f32_16x16x32_bf16 v[32:35], v[12:15], v[24:27], v[32:35]
    s_add_u32 s71, s45, s80
    s_add_u32 s71, s71, 131072
    v_mfma_f32_16x16x32_bf16 v[180:183], v[24:27], a[100:103], v[180:183]
    s_add_u32 s42, s0, s48
    s_max_u32 s42, s42, 1
    v_mfma_f32_16x16x32_bf16 v[188:191], a[100:103], a[100:103], v[188:191]
    s_waitcnt lgkmcnt(6)
    s_sub_u32 s42, s42, 1
    v_mfma_f32_16x16x32_bf16 v[96:99], v[16:19], a[96:99], v[96:99]
    s_lshr_b32 s80, s42, 1
    ds_read_b64_tr_b16 v[12:13], v1 offset:45056
    ds_read_b64_tr_b16 v[14:15], v1 offset:46080
    v_mfma_f32_16x16x32_bf16 v[100:103], v[16:19], a[100:103], v[100:103]
    s_lshl_b32 s80, s80, 12
    s_and_b32 s42, s42, 1
    v_mfma_f32_16x16x32_bf16 v[104:107], v[16:19], a[104:107], v[104:107]
    s_lshl_b32 s42, s42, 3
    s_add_u32 s42, s42, s80
    v_mfma_f32_16x16x32_bf16 v[108:111], v[16:19], a[108:111], v[108:111]
    s_add_u32 s70, s42, 22020096
    s_sub_u32 s81, s45, s70
    v_mfma_f32_16x16x32_bf16 v[176:179], v[24:27], a[112:115], v[176:179]
    s_add_u32 s70, s70, 65536
    s_lshl_b32 s42, s3, 1
    v_mfma_f32_16x16x32_bf16 v[184:187], a[112:115], a[112:115], v[184:187]
    s_waitcnt lgkmcnt(4)
    s_add_u32 s42, s42, s47
    v_mfma_f32_16x16x32_bf16 v[124:127], v[20:23], a[108:111], v[124:127]
    s_lshl_b32 s45, s0, 1
    ds_read_b64_tr_b16 v[16:17], v2 offset:36864
    ds_read_b64_tr_b16 v[18:19], v2 offset:37888
    v_mfma_f32_16x16x32_bf16 v[120:123], v[20:23], a[104:107], v[120:123]
    s_add_u32 s45, s45, s48
    s_min_u32 s80, s45, 1
    v_mfma_f32_16x16x32_bf16 v[116:119], v[20:23], a[100:103], v[116:119]
    s_sub_u32 s84, 0, s80
    s_mov_b32 s85, s84
    v_mfma_f32_16x16x32_bf16 v[112:115], v[20:23], a[96:99], v[112:115]
    s_mul_i32 s80, s80, 122880
    s_mul_i32 s45, s45, 122880
    v_mfma_f32_16x16x32_bf16 v[180:183], v[24:27], a[116:119], v[180:183]
    s_mul_i32 s64, s42, 2560
    s_add_u32 s64, s64, s45
    v_mfma_f32_16x16x32_bf16 v[188:191], a[116:119], a[116:119], v[188:191]
    s_waitcnt lgkmcnt(4)
    s_sub_u32 s65, s64, s80
    v_mfma_f32_16x16x32_bf16 v[64:67], v[8:11], a[112:115], v[64:67]
    s_mul_i32 s45, s0, 294912
    ds_read_b64_tr_b16 v[20:21], v2 offset:45056
    ds_read_b64_tr_b16 v[22:23], v2 offset:46080
    v_mfma_f32_16x16x32_bf16 v[68:71], v[8:11], a[116:119], v[68:71]
    s_add_u32 s45, s45, 8388608
    s_lshl_b32 s80, s48, 11
    v_mfma_f32_16x16x32_bf16 v[72:75], v[8:11], a[120:123], v[72:75]
    s_add_u32 s67, s45, s80
    s_add_u32 s80, s42, 48
    v_mfma_f32_16x16x32_bf16 v[76:79], v[8:11], a[124:127], v[76:79]
    s_lshl_b32 s80, s80, 12
    s_add_u32 s66, s67, s80
    v_mfma_f32_16x16x32_bf16 v[28:31], v[8:11], v[24:27], v[28:31]
    s_waitcnt vmcnt(17) lgkmcnt(4)
    s_lshr_b32 s80, s42, 2
    v_mfma_f32_16x16x32_bf16 v[92:95], v[12:15], a[124:127], v[92:95]
    s_barrier
    ds_read_b64_tr_b16 v[8:9], v1 offset:49152
    ds_read_b64_tr_b16 v[10:11], v1 offset:50176
    v_mfma_f32_16x16x32_bf16 v[88:91], v[12:15], a[120:123], v[88:91]
    s_lshl_b32 s51, s46, 11
    ds_read_b128 a[128:131], v36 offset:0
    ds_read_b128 a[132:135], v36 offset:2048
    v_mfma_f32_16x16x32_bf16 v[84:87], v[12:15], a[116:119], v[84:87]
    s_add_u32 s51, s51, 147456
    s_add_u32 m0, s41, 65536
    v_add_u32 v56, s51, v62
    v_mfma_f32_16x16x32_bf16 v[80:83], v[12:15], a[112:115], v[80:83]
    s_lshl_b32 s51, s46, 9
    s_add_u32 s51, s51, 155648
    v_lshl_add_u32 v57, v0, 2, s51
    v_mfma_f32_16x16x32_bf16 v[32:35], v[12:15], v[24:27], v[32:35]
    s_waitcnt lgkmcnt(6)
    ds_read_b128 a[136:139], v37 offset:0
    ds_read_b128 a[140:143], v37 offset:2048
    v_mfma_f32_16x16x32_bf16 v[96:99], v[16:19], a[112:115], v[96:99]
    s_mul_i32 s39, s25, 1536
    ds_read_b64_tr_b16 v[12:13], v1 offset:57344
    ds_read_b64_tr_b16 v[14:15], v1 offset:58368
    v_mfma_f32_16x16x32_bf16 v[100:103], v[16:19], a[116:119], v[100:103]
    s_add_u32 s39, s39, s43
    v_and_b32 v58, 15, v0
    v_lshrrev_b32 v59, 2, v58
    v_mfma_f32_16x16x32_bf16 v[104:107], v[16:19], a[120:123], v[104:107]
    s_add_u32 s80, s80, 64
    ds_read_b128 a[144:147], v38 offset:0
    ds_read_b128 a[148:151], v38 offset:2048
    v_mfma_f32_16x16x32_bf16 v[108:111], v[16:19], a[124:127], v[108:111]
    s_waitcnt lgkmcnt(10)
    v_lshl_add_u32 v59, v59, 4, v58
    v_and_b32 v58, 3, v0
    v_mfma_f32_16x16x32_bf16 v[124:127], v[20:23], a[124:127], v[124:127]
    s_lshl_b32 s80, s80, 4
    ds_read_b64_tr_b16 v[16:17], v2 offset:49152
    ds_read_b64_tr_b16 v[18:19], v2 offset:50176
    v_mfma_f32_16x16x32_bf16 v[120:123], v[20:23], a[120:123], v[120:123]
    s_and_b32 s42, s42, 3
    ds_read_b128 a[152:155], v39 offset:0
    ds_read_b128 a[156:159], v39 offset:2048
    v_mfma_f32_16x16x32_bf16 v[116:119], v[20:23], a[116:119], v[116:119]
    s_lshl_b32 s51, s46, 11
    v_lshlrev_b32 v58, 2, v58
    v_lshl_add_u32 v58, v59, 4, v58
    v_mfma_f32_16x16x32_bf16 v[112:115], v[20:23], a[112:115], v[112:115]
    s_waitcnt lgkmcnt(11)
    s_add_u32 s51, s51, 147456
    v_add_u32 v58, s51, v58
    v_mfma_f32_16x16x32_bf16 v[64:67], v[8:11], a[128:131], v[64:67]
    s_waitcnt lgkmcnt(10)
    s_add_u32 s80, s80, s42
    ds_read_b64_tr_b16 v[20:21], v2 offset:57344
    ds_read_b64_tr_b16 v[22:23], v2 offset:58368
    v_mfma_f32_16x16x32_bf16 v[68:71], v[8:11], a[132:135], v[68:71]
    s_waitcnt lgkmcnt(11)
    s_lshl_b32 s80, s80, 8
    v_xor_b32 v59, 0x800, v58
    v_xor_b32 v42, 0x200, v57
    v_mfma_f32_16x16x32_bf16 v[72:75], v[8:11], a[136:139], v[72:75]
    s_waitcnt lgkmcnt(10)
    buffer_load_dwordx4 v60, s[12:15], s39 offen offset:0 lds
    v_mfma_f32_16x16x32_bf16 v[76:79], v[8:11], a[140:143], v[76:79]
    s_waitcnt vmcnt(13)
    s_add_u32 s39, s39, 11264
    s_add_u32 s67, s67, s80
    v_cmp_gt_u32 vcc, 1, v140
    v_mfma_f32_16x16x32_bf16 v[28:31], v[8:11], v[24:27], v[28:31]
    s_cbranch_vccnz K_slow9
K_back9:
    s_and_b32 s80, s3, 0
    v_mfma_f32_16x16x32_bf16 v[176:179], v[24:27], a[128:131], v[176:179]
    s_waitcnt vmcnt(9)
    buffer_store_dword v24, v3, s[16:19], 0 offen sc1
    v_mfma_f32_16x16x32_bf16 v[184:187], a[128:131], a[128:131], v[184:187]
    s_waitcnt lgkmcnt(8)
    s_xor_b32 s80, s80, s46
    v_mfma_f32_16x16x32_bf16 v[92:95], v[12:15], a[140:143], v[92:95]
    s_lshl_b32 s42, s0, 2
    ds_read_b64_tr_b16 v[8:9], v1 offset:53248
    ds_read_b64_tr_b16 v[10:11], v1 offset:54272
    v_mfma_f32_16x16x32_bf16 v[88:91], v[12:15], a[136:139], v[88:91]
    buffer_load_dwordx4 v60, s[12:15], s39 offen offset:1024 lds
    v_mfma_f32_16x16x32_bf16 v[84:87], v[12:15], a[132:135], v[84:87]
    s_add_u32 s39, s39, 35840
    s_add_u32 s42, s42, s80
    v_mfma_f32_16x16x32_bf16 v[80:83], v[12:15], a[128:131], v[80:83]
    s_lshl_b32 s80, s80, 10
    s_add_u32 s45, s45, s80
    v_mfma_f32_16x16x32_bf16 v[32:35], v[12:15], v[24:27], v[32:35]
    s_mul_i32 s42, s42, 20480
    s_mul_i32 s80, s3, 160
    v_mfma_f32_16x16x32_bf16 v[180:183], v[24:27], a[132:135], v[180:183]
    s_add_u32 s68, s42, s80
    s_mul_i32 s42, s3, 5120
    v_mfma_f32_16x16x32_bf16 v[188:191], a[132:135], a[132:135], v[188:191]
    s_waitcnt lgkmcnt(6)
    s_add_u32 s73, s42, 17825792
    v_mfma_f32_16x16x32_bf16 v[96:99], v[16:19], a[128:131], v[96:99]
    s_lshr_b32 s42, s0, 1
    ds_read_b64_tr_b16 v[12:13], v1 offset:61440
    ds_read_b64_tr_b16 v[14:15], v1 offset:62464
    v_mfma_f32_16x16x32_bf16 v[100:103], v[16:19], a[132:135], v[100:103]
    buffer_load_dwordx4 v60, s[12:15], s39 offen offset:2048 lds
    v_mfma_f32_16x16x32_bf16 v[104:107], v[16:19], a[136:139], v[104:107]
    s_add_u32 s39, s39, 11264
    s_xor_b32 s42, s42, s3
    v_mfma_f32_16x16x32_bf16 v[108:111], v[16:19], a[140:143], v[108:111]
    s_and_b32 s42, s42, 3
    s_lshl_b32 s80, s46, 2
    v_mfma_f32_16x16x32_bf16 v[176:179], v[24:27], a[144:147], v[176:179]
    s_add_u32 s42, s42, s80
    s_add_u32 s74, s42, 32
    v_mfma_f32_16x16x32_bf16 v[184:187], a[144:147], a[144:147], v[184:187]
    s_waitcnt lgkmcnt(4)
    s_lshl_b32 s42, s42, 1
    v_mfma_f32_16x16x32_bf16 v[124:127], v[20:23], a[140:143], v[124:127]
    s_and_b32 s80, s0, 1
    ds_read_b64_tr_b16 v[16:17], v2 offset:53248
    ds_read_b64_tr_b16 v[18:19], v2 offset:54272
    v_mfma_f32_16x16x32_bf16 v[120:123], v[20:23], a[136:139], v[120:123]
    buffer_load_dwordx4 v60, s[12:15], s39 offen offset:3072 lds
    v_mfma_f32_16x16x32_bf16 v[116:119], v[20:23], a[132:135], v[116:119]
    s_add_u32 s75, s42, s80
    s_lshl_b32 s42, s74, 12
    v_mfma_f32_16x16x32_bf16 v[112:115], v[20:23], a[128:131], v[112:115]
    s_add_u32 s77, s45, s42
    s_lshl_b32 s42, s75, 12
    v_mfma_f32_16x16x32_bf16 v[180:183], v[24:27], a[148:151], v[180:183]
    s_add_u32 s78, s45, s42
    s_mul_i32 s42, s46, 5
    v_mfma_f32_16x16x32_bf16 v[188:191], a[148:151], a[148:151], v[188:191]
    s_waitcnt lgkmcnt(4)
    s_add_u32 s42, s42, 48
    v_mfma_f32_16x16x32_bf16 v[64:67], v[8:11], a[144:147], v[64:67]
    s_lshl_b32 s80, s42, 12
    ds_read_b64_tr_b16 v[20:21], v2 offset:61440
    ds_read_b64_tr_b16 v[22:23], v2 offset:62464
    v_mfma_f32_16x16x32_bf16 v[68:71], v[8:11], a[148:151], v[68:71]
    s_add_u32 s79, s45, s80
    s_mul_i32 s42, s42, 40960
    v_mfma_f32_16x16x32_bf16 v[72:75], v[8:11], a[152:155], v[72:75]
    s_add_u32 s76, s42, s73
    s_and_b32 s42, s49, 7
    v_mfma_f32_16x16x32_bf16 v[76:79], v[8:11], a[156:159], v[76:79]
    s_and_b32 s80, s50, 3
    s_add_u32 s42, s42, s80
    v_mfma_f32_16x16x32_bf16 v[28:31], v[8:11], v[24:27], v[28:31]
    s_waitcnt vmcnt(9) lgkmcnt(4)
    s_lshl_b32 s42, s42, 12
    v_add_u32 v1, 65536, v1
    v_mfma_f32_16x16x32_bf16 v[92:95], v[12:15], a[156:159], v[92:95]
    s_barrier
    ds_read_b64_tr_b16 v[8:9], v1 offset:0
    ds_read_b64_tr_b16 v[10:11], v1 offset:1024
    v_mfma_f32_16x16x32_bf16 v[88:91], v[12:15], a[152:155], v[88:91]
    s_add_u32 m0, s41, 49152
    ds_read_b128 a[160:163], v36 offset:16384
    ds_read_b128 a[164:167], v36 offset:18432
    v_mfma_f32_16x16x32_bf16 v[84:87], v[12:15], a[148:151], v[84:87]
    s_mul_i32 s39, s26, 1536
    s_add_u32 s39, s39, s43
    v_mfma_f32_16x16x32_bf16 v[80:83], v[12:15], a[144:147], v[80:83]
    buffer_load_dwordx4 v60, s[12:15], s39 offen offset:0 lds
    v_mfma_f32_16x16x32_bf16 v[32:35], v[12:15], v[24:27], v[32:35]
    s_waitcnt lgkmcnt(6)
    ds_read_b128 a[168:171], v37 offset:16384
    ds_read_b128 a[172:175], v37 offset:18432
    v_mfma_f32_16x16x32_bf16 v[96:99], v[16:19], a[144:147], v[96:99]
    s_add_u32 s39, s39, 11264
    ds_read_b64_tr_b16 v[12:13], v1 offset:8192
    ds_read_b64_tr_b16 v[14:15], v1 offset:9216
    v_mfma_f32_16x16x32_bf16 v[100:103], v[16:19], a[148:151], v[100:103]
    s_sub_u32 s80, s42, 20480
    s_min_u32 s42, s42, s80
    v_mfma_f32_16x16x32_bf16 v[104:107], v[16:19], a[152:155], v[104:107]
    ds_read_b128 a[176:179], v38 offset:16384
    ds_read_b128 a[180:183], v38 offset:18432
    v_mfma_f32_16x16x32_bf16 v[108:111], v[16:19], a[156:159], v[108:111]
    s_waitcnt lgkmcnt(10)
    v_add_u32 v2, 65536, v2
    v_mfma_f32_16x16x32_bf16 v[124:127], v[20:23], a[156:159], v[124:127]
    ds_read_b64_tr_b16 v[16:17], v2 offset:0
    ds_read_b64_tr_b16 v[18:19], v2 offset:1024
    v_mfma_f32_16x16x32_bf16 v[120:123], v[20:23], a[152:155], v[120:123]
    ds_read_b128 a[184:187], v39 offset:16384
    ds_read_b128 a[188:191], v39 offset:18432
    v_mfma_f32_16x16x32_bf16 v[116:119], v[20:23], a[148:151], v[116:119]
    buffer_load_dwordx4 v60, s[12:15], s39 offen offset:1024 lds
    v_mfma_f32_16x16x32_bf16 v[112:115], v[20:23], a[144:147], v[112:115]
    s_waitcnt lgkmcnt(11)
    s_add_u32 s39, s39, 35840
    v_mfma_f32_16x16x32_bf16 v[64:67], v[8:11], a[160:163], v[64:67]
    s_waitcnt lgkmcnt(10)
    ds_read_b64_tr_b16 v[20:21], v2 offset:8192
    ds_read_b64_tr_b16 v[22:23], v2 offset:9216
    v_mfma_f32_16x16x32_bf16 v[68:71], v[8:11], a[164:167], v[68:71]
    s_waitcnt lgkmcnt(11)
    v_mfma_f32_16x16x32_bf16 v[72:75], v[8:11], a[168:171], v[72:75]
    s_waitcnt lgkmcnt(10)
    v_mfma_f32_16x16x32_bf16 v[76:79], v[8:11], a[172:175], v[76:79]
    v_mfma_f32_16x16x32_bf16 v[28:31], v[8:11], v[24:27], v[28:31]
    buffer_load_dwordx4 v60, s[12:15], s39 offen offset:2048 lds
    v_mfma_f32_16x16x32_bf16 v[176:179], v[24:27], a[160:163], v[176:179]
    s_add_u32 s39, s39, 11264
    v_mfma_f32_16x16x32_bf16 v[184:187], a[160:163], a[160:163], v[184:187]
    s_waitcnt lgkmcnt(8)
    v_mfma_f32_16x16x32_bf16 v[92:95], v[12:15], a[172:175], v[92:95]
    ds_read_b64_tr_b16 v[8:9], v1 offset:4096
    ds_read_b64_tr_b16 v[10:11], v1 offset:5120
    v_mfma_f32_16x16x32_bf16 v[88:91], v[12:15], a[168:171], v[88:91]
    v_mfma_f32_16x16x32_bf16 v[84:87], v[12:15], a[164:167], v[84:87]
    v_mfma_f32_16x16x32_bf16 v[80:83], v[12:15], a[160:163], v[80:83]
    buffer_load_dwordx4 v60, s[12:15], s39 offen offset:3072 lds
    v_mfma_f32_16x16x32_bf16 v[32:35], v[12:15], v[24:27], v[32:35]
    v_mfma_f32_16x16x32_bf16 v[180:183], v[24:27], a[164:167], v[180:183]
    v_mfma_f32_16x16x32_bf16 v[188:191], a[164:167], a[164:167], v[188:191]
    s_waitcnt lgkmcnt(6)
    v_mfma_f32_16x16x32_bf16 v[96:99], v[16:19], a[160:163], v[96:99]
    ds_read_b64_tr_b16 v[12:13], v1 offset:12288
    ds_read_b64_tr_b16 v[14:15], v1 offset:13312
    v_mfma_f32_16x16x32_bf16 v[100:103], v[16:19], a[164:167], v[100:103]
    v_mfma_f32_16x16x32_bf16 v[104:107], v[16:19], a[168:171], v[104:107]
    v_mfma_f32_16x16x32_bf16 v[108:111], v[16:19], a[172:175], v[108:111]
    v_mfma_f32_16x16x32_bf16 v[176:179], v[24:27], a[176:179], v[176:179]
    v_mfma_f32_16x16x32_bf16 v[184:187], a[176:179], a[176:179], v[184:187]
    s_waitcnt lgkmcnt(4)
    v_mfma_f32_16x16x32_bf16 v[124:127], v[20:23], a[172:175], v[124:127]
    ds_read_b64_tr_b16 v[16:17], v2 offset:4096
    ds_read_b64_tr_b16 v[18:19], v2 offset:5120
    v_mfma_f32_16x16x32_bf16 v[120:123], v[20:23], a[168:171], v[120:123]
    v_mfma_f32_16x16x32_bf16 v[116:119], v[20:23], a[164:167], v[116:119]
    v_mfma_f32_16x16x32_bf16 v[112:115], v[20:23], a[160:163], v[112:115]
    v_mfma_f32_16x16x32_bf16 v[180:183], v[24:27], a[180:183], v[180:183]
    v_mfma_f32_16x16x32_bf16 v[188:191], a[180:183], a[180:183], v[188:191]
    s_waitcnt lgkmcnt(4)
    v_mfma_f32_16x16x32_bf16 v[64:67], v[8:11], a[176:179], v[64:67]
    ds_read_b64_tr_b16 v[20:21], v2 offset:12288
    ds_read_b64_tr_b16 v[22:23], v2 offset:13312
    v_mfma_f32_16x16x32_bf16 v[68:71], v[8:11], a[180:183], v[68:71]
    v_mfma_f32_16x16x32_bf16 v[72:75], v[8:11], a[184:187], v[72:75]
    v_mfma_f32_16x16x32_bf16 v[76:79], v[8:11], a[188:191], v[76:79]
    v_mfma_f32_16x16x32_bf16 v[28:31], v[8:11], v[24:27], v[28:31]
    s_waitcnt vmcnt(9) lgkmcnt(4)
    v_add_u32 v1, 4294868992, v1
    v_mfma_f32_16x16x32_bf16 v[92:95], v[12:15], a[188:191], v[92:95]
    s_barrier
    ds_read_b64_tr_b16 v[8:9], v1 offset:0
    ds_read_b64_tr_b16 v[10:11], v1 offset:1024
    v_mfma_f32_16x16x32_bf16 v[88:91], v[12:15], a[184:187], v[88:91]
    s_add_u32 m0, s41, 81920
    ds_write_b128 v56, v[184:187]
    v_mfma_f32_16x16x32_bf16 v[84:87], v[12:15], a[180:183], v[84:87]
    s_mul_i32 s39, s27, 1536
    s_add_u32 s39, s39, s43
    v_mfma_f32_16x16x32_bf16 v[80:83], v[12:15], a[176:179], v[80:83]
    buffer_load_dwordx4 v60, s[12:15], s39 offen offset:0 lds
    v_mfma_f32_16x16x32_bf16 v[32:35], v[12:15], v[24:27], v[32:35]
    s_waitcnt lgkmcnt(5)
    s_add_u32 s39, s39, 11264
    v_mfma_f32_16x16x32_bf16 v[96:99], v[16:19], a[176:179], v[96:99]
    ds_read_b64_tr_b16 v[12:13], v1 offset:8192
    ds_read_b64_tr_b16 v[14:15], v1 offset:9216
    v_mfma_f32_16x16x32_bf16 v[100:103], v[16:19], a[180:183], v[100:103]
    ds_write_b128 v7, v[28:31] offset:0
    v_mfma_f32_16x16x32_bf16 v[104:107], v[16:19], a[184:187], v[104:107]
    buffer_load_dwordx4 v60, s[12:15], s39 offen offset:1024 lds
    v_mfma_f32_16x16x32_bf16 v[108:111], v[16:19], a[188:191], v[108:111]
    s_waitcnt lgkmcnt(6)
    s_add_u32 s39, s39, 35840
    v_add_u32 v2, 4294868992, v2
    v_mfma_f32_16x16x32_bf16 v[124:127], v[20:23], a[188:191], v[124:127]
    ds_read_b64_tr_b16 v[16:17], v2 offset:0
    ds_read_b64_tr_b16 v[18:19], v2 offset:1024
    v_mfma_f32_16x16x32_bf16 v[120:123], v[20:23], a[184:187], v[120:123]
    ds_write_b128 v56, v[188:191] offset:1024
    v_mfma_f32_16x16x32_bf16 v[116:119], v[20:23], a[180:183], v[116:119]
    buffer_load_dwordx4 v60, s[12:15], s39 offen offset:2048 lds
    v_mfma_f32_16x16x32_bf16 v[112:115], v[20:23], a[176:179], v[112:115]
    s_waitcnt lgkmcnt(7)
    s_add_u32 s39, s39, 11264
    v_mfma_f32_16x16x32_bf16 v[128:131], v[8:11], v[192:195], 0
    ds_read_b64_tr_b16 v[20:21], v2 offset:8192
    ds_read_b64_tr_b16 v[22:23], v2 offset:9216
    v_mfma_f32_16x16x32_bf16 v[132:135], v[8:11], v[196:199], 0
    ds_write_b128 v7, v[32:35] offset:256
    v_mfma_f32_16x16x32_bf16 v[136:139], v[8:11], v[200:203], 0
    buffer_load_dwordx4 v60, s[12:15], s39 offen offset:3072 lds
    v_mfma_f32_16x16x32_bf16 v[140:143], v[8:11], v[204:207], 0
    s_add_u32 m0, s41, 0
    s_mul_i32 s39, s28, 1536
    v_mfma_f32_16x16x32_bf16 v[28:31], v[8:11], v[24:27], 0
    s_waitcnt lgkmcnt(7)
    ds_write_b32 v57, v176
    v_mfma_f32_16x16x32_bf16 v[156:159], v[12:15], v[204:207], 0
    s_add_u32 s39, s39, s43
    ds_read_b64_tr_b16 v[8:9], v1 offset:4096
    ds_read_b64_tr_b16 v[10:11], v1 offset:5120
    v_mfma_f32_16x16x32_bf16 v[152:155], v[12:15], v[200:203], 0
    ds_write_b32 v57, v180 offset:256
    v_mfma_f32_16x16x32_bf16 v[148:151], v[12:15], v[196:199], 0
    buffer_load_dwordx4 v60, s[12:15], s39 offen offset:0 lds
    v_mfma_f32_16x16x32_bf16 v[144:147], v[12:15], v[192:195], 0
    s_add_u32 s39, s39, 11264
    v_mfma_f32_16x16x32_bf16 v[32:35], v[12:15], v[24:27], 0
    s_waitcnt lgkmcnt(8)
    v_mfma_f32_16x16x32_bf16 v[160:163], v[16:19], v[192:195], 0
    ds_read_b64_tr_b16 v[12:13], v1 offset:12288
    ds_read_b64_tr_b16 v[14:15], v1 offset:13312
    v_mfma_f32_16x16x32_bf16 v[164:167], v[16:19], v[196:199], 0
    buffer_load_dwordx4 v60, s[12:15], s39 offen offset:1024 lds
    v_mfma_f32_16x16x32_bf16 v[168:171], v[16:19], v[200:203], 0
    s_add_u32 s39, s39, 35840
    v_mfma_f32_16x16x32_bf16 v[172:175], v[16:19], v[204:207], 0
    s_waitcnt lgkmcnt(7)
    v_mfma_f32_16x16x32_bf16 v[188:191], v[20:23], v[204:207], 0
    ds_read_b64_tr_b16 v[16:17], v2 offset:4096
    ds_read_b64_tr_b16 v[18:19], v2 offset:5120
    v_mfma_f32_16x16x32_bf16 v[184:187], v[20:23], v[200:203], 0
    buffer_load_dwordx4 v60, s[12:15], s39 offen offset:2048 lds
    v_mfma_f32_16x16x32_bf16 v[180:183], v[20:23], v[196:199], 0
    s_add_u32 s39, s39, 11264
    v_mfma_f32_16x16x32_bf16 v[176:179], v[20:23], v[192:195], 0
    s_waitcnt lgkmcnt(5)
    v_mfma_f32_16x16x32_bf16 v[128:131], v[8:11], v[208:211], v[128:131]
    ds_read_b64_tr_b16 v[20:21], v2 offset:12288
    ds_read_b64_tr_b16 v[22:23], v2 offset:13312
    v_mfma_f32_16x16x32_bf16 v[132:135], v[8:11], v[212:215], v[132:135]
    buffer_load_dwordx4 v60, s[12:15], s39 offen offset:3072 lds
    v_mfma_f32_16x16x32_bf16 v[136:139], v[8:11], v[216:219], v[136:139]
    v_mfma_f32_16x16x32_bf16 v[140:143], v[8:11], v[220:223], v[140:143]
    v_mfma_f32_16x16x32_bf16 v[28:31], v[8:11], v[24:27], v[28:31]
    s_waitcnt vmcnt(12) lgkmcnt(4)
    v_mfma_f32_16x16x32_bf16 v[156:159], v[12:15], v[220:223], v[156:159]
    s_barrier
    ds_read_b64_tr_b16 v[8:9], v1 offset:32768
    ds_read_b64_tr_b16 v[10:11], v1 offset:33792
    v_mfma_f32_16x16x32_bf16 v[152:155], v[12:15], v[216:219], v[152:155]
    s_add_u32 m0, s41, 98304
    ds_read_b32 v52, v58
    ds_read_b32 v53, v58 offset:1024
    v_mfma_f32_16x16x32_bf16 v[148:151], v[12:15], v[212:215], v[148:151]
    s_mul_i32 s39, s29, 1536
    ds_read_b32 v54, v59
    ds_read_b32 v55, v59 offset:1024
    v_mfma_f32_16x16x32_bf16 v[144:147], v[12:15], v[208:211], v[144:147]
    s_add_u32 s39, s39, s43
    ds_read_b32 v44, v57
    ds_read_b32 v45, v57 offset:256
    v_mfma_f32_16x16x32_bf16 v[32:35], v[12:15], v[24:27], v[32:35]
    s_waitcnt lgkmcnt(10)
    ds_read_b32 v46, v42
    ds_read_b32 v47, v42 offset:256
    v_mfma_f32_16x16x32_bf16 v[160:163], v[16:19], v[208:211], v[160:163]
    ds_read_b64_tr_b16 v[12:13], v1 offset:40960
    ds_read_b64_tr_b16 v[14:15], v1 offset:41984
    v_mfma_f32_16x16x32_bf16 v[164:167], v[16:19], v[212:215], v[164:167]
    ds_read_b128 v[36:39], v7 offset:0
    ds_read_b128 v[40:43], v7 offset:256
    v_mfma_f32_16x16x32_bf16 v[168:171], v[16:19], v[216:219], v[168:171]
    buffer_load_dwordx4 v60, s[12:15], s39 offen offset:0 lds
    v_mfma_f32_16x16x32_bf16 v[172:175], v[16:19], v[220:223], v[172:175]
    s_waitcnt lgkmcnt(14)
    s_add_u32 s39, s39, 11264
    v_mfma_f32_16x16x32_bf16 v[188:191], v[20:23], v[220:223], v[188:191]
    ds_read_b64_tr_b16 v[16:17], v2 offset:32768
    ds_read_b64_tr_b16 v[18:19], v2 offset:33792
    v_mfma_f32_16x16x32_bf16 v[184:187], v[20:23], v[216:219], v[184:187]
    buffer_load_dwordx4 v60, s[12:15], s39 offen offset:1024 lds
    v_mfma_f32_16x16x32_bf16 v[180:183], v[20:23], v[212:215], v[180:183]
    s_add_u32 s39, s39, 35840
    v_mfma_f32_16x16x32_bf16 v[176:179], v[20:23], v[208:211], v[176:179]
    s_waitcnt lgkmcnt(14)
    v_mfma_f32_16x16x32_bf16 v[128:131], v[8:11], v[224:227], v[128:131]
    ds_read_b64_tr_b16 v[20:21], v2 offset:40960
    ds_read_b64_tr_b16 v[22:23], v2 offset:41984
    v_mfma_f32_16x16x32_bf16 v[132:135], v[8:11], v[228:231], v[132:135]
    buffer_load_dwordx4 v60, s[12:15], s39 offen offset:2048 lds
    v_mfma_f32_16x16x32_bf16 v[136:139], v[8:11], v[232:235], v[136:139]
    s_add_u32 s39, s39, 11264
    v_mfma_f32_16x16x32_bf16 v[140:143], v[8:11], v[236:239], v[140:143]
    v_mfma_f32_16x16x32_bf16 v[28:31], v[8:11], v[24:27], v[28:31]
    s_waitcnt lgkmcnt(6)
    buffer_load_dwordx4 v60, s[12:15], s39 offen offset:3072 lds
    v_mfma_f32_16x16x32_bf16 v[156:159], v[12:15], v[236:239], v[156:159]
    s_add_u32 m0, s41, 16384
    ds_read_b64_tr_b16 v[8:9], v1 offset:36864
    ds_read_b64_tr_b16 v[10:11], v1 offset:37888
    v_mfma_f32_16x16x32_bf16 v[152:155], v[12:15], v[232:235], v[152:155]
    s_mul_i32 s39, s30, 1536
    s_add_u32 s39, s39, s43
    v_mul_f32 v44, 0xbacccccd, v44
    v_mfma_f32_16x16x32_bf16 v[148:151], v[12:15], v[228:231], v[148:151]
    buffer_load_dwordx4 v60, s[12:15], s39 offen offset:0 lds
    v_mfma_f32_16x16x32_bf16 v[144:147], v[12:15], v[224:227], v[144:147]
    s_add_u32 s39, s39, 11264
    v_mul_f32 v45, 0xbacccccd, v45
    v_mul_f32 v46, 0xbacccccd, v46
    v_mfma_f32_16x16x32_bf16 v[32:35], v[12:15], v[24:27], v[32:35]
    s_waitcnt lgkmcnt(4)
    v_mul_f32 v47, 0xbacccccd, v47
    v_mul_f32 v52, 0x3acccccd, v52
    v_mfma_f32_16x16x32_bf16 v[160:163], v[16:19], v[224:227], v[160:163]
    ds_read_b64_tr_b16 v[12:13], v1 offset:45056
    ds_read_b64_tr_b16 v[14:15], v1 offset:46080
    v_mfma_f32_16x16x32_bf16 v[164:167], v[16:19], v[228:231], v[164:167]
    buffer_load_dwordx4 v60, s[12:15], s39 offen offset:1024 lds
    v_mfma_f32_16x16x32_bf16 v[168:171], v[16:19], v[232:235], v[168:171]
    s_add_u32 s39, s39, 35840
    v_mul_f32 v53, 0x3acccccd, v53
    v_mul_f32 v54, 0x3acccccd, v54
    v_mfma_f32_16x16x32_bf16 v[172:175], v[16:19], v[236:239], v[172:175]
    s_waitcnt lgkmcnt(4)
    v_mul_f32 v55, 0x3acccccd, v55
    v_fma_f32 v52, -v44, v44, v52
    v_mfma_f32_16x16x32_bf16 v[188:191], v[20:23], v[236:239], v[188:191]
    ds_read_b64_tr_b16 v[16:17], v2 offset:36864
    ds_read_b64_tr_b16 v[18:19], v2 offset:37888
    v_mfma_f32_16x16x32_bf16 v[184:187], v[20:23], v[232:235], v[184:187]
    buffer_load_dwordx4 v60, s[12:15], s39 offen offset:2048 lds
    v_mfma_f32_16x16x32_bf16 v[180:183], v[20:23], v[228:231], v[180:183]
    s_add_u32 s39, s39, 11264
    v_fma_f32 v53, -v45, v45, v53
    v_fma_f32 v54, -v46, v46, v54
    v_mfma_f32_16x16x32_bf16 v[176:179], v[20:23], v[224:227], v[176:179]
    s_waitcnt lgkmcnt(4)
    v_fma_f32 v55, -v47, v47, v55
    v_max_f32 v52, 0, v52
    v_mfma_f32_16x16x32_bf16 v[128:131], v[8:11], v[240:243], v[128:131]
    ds_read_b64_tr_b16 v[20:21], v2 offset:45056
    ds_read_b64_tr_b16 v[22:23], v2 offset:46080
    v_mfma_f32_16x16x32_bf16 v[132:135], v[8:11], v[244:247], v[132:135]
    buffer_load_dwordx4 v60, s[12:15], s39 offen offset:3072 lds
    v_mfma_f32_16x16x32_bf16 v[136:139], v[8:11], v[248:251], v[136:139]
    v_max_f32 v53, 0, v53
    v_max_f32 v54, 0, v54
    v_mfma_f32_16x16x32_bf16 v[140:143], v[8:11], v[252:255], v[140:143]
    v_max_f32 v55, 0, v55
    v_add_f32 v52, 0x3727c5ac, v52
    v_mfma_f32_16x16x32_bf16 v[28:31], v[8:11], v[24:27], v[28:31]
    s_waitcnt vmcnt(16) lgkmcnt(4)
    v_rsq_f32 v48, v52
    v_mfma_f32_16x16x32_bf16 v[156:159], v[12:15], v[252:255], v[156:159]
    s_barrier
    ds_read_b64_tr_b16 v[8:9], v1 offset:16384
    ds_read_b64_tr_b16 v[10:11], v1 offset:17408
    v_mfma_f32_16x16x32_bf16 v[152:155], v[12:15], v[248:251], v[152:155]
    s_add_u32 m0, s41, 114688
    s_mul_i32 s39, s31, 1536
    v_add_f32 v53, 0x3727c5ac, v53
    v_mfma_f32_16x16x32_bf16 v[148:151], v[12:15], v[244:247], v[148:151]
    s_add_u32 s39, s39, s43
    v_rsq_f32 v49, v53
    v_mfma_f32_16x16x32_bf16 v[144:147], v[12:15], v[240:243], v[144:147]
    buffer_load_dwordx4 v60, s[12:15], s39 offen offset:0 lds
    v_mfma_f32_16x16x32_bf16 v[32:35], v[12:15], v[24:27], v[32:35]
    s_waitcnt lgkmcnt(4)
    s_add_u32 s39, s39, 11264
    v_add_f32 v54, 0x3727c5ac, v54
    v_mfma_f32_16x16x32_bf16 v[160:163], v[16:19], v[240:243], v[160:163]
    ds_read_b64_tr_b16 v[12:13], v1 offset:24576
    ds_read_b64_tr_b16 v[14:15], v1 offset:25600
    v_mfma_f32_16x16x32_bf16 v[164:167], v[16:19], v[244:247], v[164:167]
    v_rsq_f32 v50, v54
    v_mfma_f32_16x16x32_bf16 v[168:171], v[16:19], v[248:251], v[168:171]
    buffer_load_dwordx4 v60, s[12:15], s39 offen offset:1024 lds
    v_mfma_f32_16x16x32_bf16 v[172:175], v[16:19], v[252:255], v[172:175]
    s_waitcnt lgkmcnt(4)
    s_add_u32 s39, s39, 35840
    v_add_f32 v55, 0x3727c5ac, v55
    v_mfma_f32_16x16x32_bf16 v[188:191], v[20:23], v[252:255], v[188:191]
    ds_read_b64_tr_b16 v[16:17], v2 offset:16384
    ds_read_b64_tr_b16 v[18:19], v2 offset:17408
    v_mfma_f32_16x16x32_bf16 v[184:187], v[20:23], v[248:251], v[184:187]
    v_rsq_f32 v51, v55
    v_mfma_f32_16x16x32_bf16 v[180:183], v[20:23], v[244:247], v[180:183]
    buffer_load_dwordx4 v60, s[12:15], s39 offen offset:2048 lds
    v_mfma_f32_16x16x32_bf16 v[176:179], v[20:23], v[240:243], v[176:179]
    s_waitcnt lgkmcnt(4)
    s_add_u32 s39, s39, 11264
    v_mul_f32 v48, s59, v48
    v_mfma_f32_16x16x32_bf16 v[128:131], v[8:11], a[192:195], v[128:131]
    ds_read_b64_tr_b16 v[20:21], v2 offset:24576
    ds_read_b64_tr_b16 v[22:23], v2 offset:25600
    v_mfma_f32_16x16x32_bf16 v[132:135], v[8:11], a[196:199], v[132:135]
    v_mul_f32 v49, s59, v49
    v_mul_f32 v50, s59, v50
    v_mfma_f32_16x16x32_bf16 v[136:139], v[8:11], a[200:203], v[136:139]
    buffer_load_dwordx4 v60, s[12:15], s39 offen offset:3072 lds
    v_mfma_f32_16x16x32_bf16 v[140:143], v[8:11], a[204:207], v[140:143]
    s_add_u32 m0, s41, 131072
    s_mul_i32 s39, s32, 1536
    v_mul_f32 v51, s59, v51
    v_mfma_f32_16x16x32_bf16 v[28:31], v[8:11], v[24:27], v[28:31]
    s_waitcnt lgkmcnt(4)
    s_add_u32 s39, s39, s43
    v_mul_f32 v52, 0x3f317218, v52
    v_mfma_f32_16x16x32_bf16 v[156:159], v[12:15], a[204:207], v[156:159]
    ds_read_b64_tr_b16 v[8:9], v1 offset:20480
    ds_read_b64_tr_b16 v[10:11], v1 offset:21504
    v_mfma_f32_16x16x32_bf16 v[152:155], v[12:15], a[200:203], v[152:155]
    buffer_load_dwordx4 v60, s[12:15], s39 offen offset:0 lds
    v_mfma_f32_16x16x32_bf16 v[148:151], v[12:15], a[196:199], v[148:151]
    s_add_u32 s39, s39, 11264
    v_mul_f32 v53, 0x3f317218, v53
    v_mul_f32 v54, 0x3f317218, v54
    v_mfma_f32_16x16x32_bf16 v[144:147], v[12:15], a[192:195], v[144:147]
    v_mul_f32 v55, 0x3f317218, v55
    v_fmac_f32 v64, v44, v36
    v_mfma_f32_16x16x32_bf16 v[32:35], v[12:15], v[24:27], v[32:35]
    s_waitcnt lgkmcnt(4)
    v_fmac_f32 v65, v44, v37
    v_fmac_f32 v66, v44, v38
    v_mfma_f32_16x16x32_bf16 v[160:163], v[16:19], a[192:195], v[160:163]
    ds_read_b64_tr_b16 v[12:13], v1 offset:28672
    ds_read_b64_tr_b16 v[14:15], v1 offset:29696
    v_mfma_f32_16x16x32_bf16 v[164:167], v[16:19], a[196:199], v[164:167]
    buffer_load_dwordx4 v60, s[12:15], s39 offen offset:1024 lds
    v_mfma_f32_16x16x32_bf16 v[168:171], v[16:19], a[200:203], v[168:171]
    s_add_u32 s39, s39, 35840
    v_fmac_f32 v67, v44, v39
    v_mul_f32 v64, v48, v64
    v_mfma_f32_16x16x32_bf16 v[172:175], v[16:19], a[204:207], v[172:175]
    s_waitcnt lgkmcnt(4)
    v_mul_f32 v65, v48, v65
    v_mul_f32 v66, v48, v66
    v_mfma_f32_16x16x32_bf16 v[188:191], v[20:23], a[204:207], v[188:191]
    ds_read_b64_tr_b16 v[16:17], v2 offset:20480
    ds_read_b64_tr_b16 v[18:19], v2 offset:21504
    v_mfma_f32_16x16x32_bf16 v[184:187], v[20:23], a[200:203], v[184:187]
    buffer_load_dwordx4 v60, s[12:15], s39 offen offset:2048 lds
    v_mfma_f32_16x16x32_bf16 v[180:183], v[20:23], a[196:199], v[180:183]
    s_add_u32 s39, s39, 11264
    v_mul_f32 v67, v48, v67
    v_cvt_pk_bf16_f32 v64, v64, v65
    v_mfma_f32_16x16x32_bf16 v[176:179], v[20:23], a[192:195], v[176:179]
    s_waitcnt lgkmcnt(4)
    v_cvt_pk_bf16_f32 v65, v66, v67
    v_fmac_f32 v68, v45, v36
    v_mfma_f32_16x16x32_bf16 v[128:131], v[8:11], a[208:211], v[128:131]
    ds_read_b64_tr_b16 v[20:21], v2 offset:28672
    ds_read_b64_tr_b16 v[22:23], v2 offset:29696
    v_mfma_f32_16x16x32_bf16 v[132:135], v[8:11], a[212:215], v[132:135]
    buffer_load_dwordx4 v60, s[12:15], s39 offen offset:3072 lds
    v_mfma_f32_16x16x32_bf16 v[136:139], v[8:11], a[216:219], v[136:139]
    v_fmac_f32 v69, v45, v37
    v_fmac_f32 v70, v45, v38
    v_mfma_f32_16x16x32_bf16 v[140:143], v[8:11], a[220:223], v[140:143]
    v_fmac_f32 v71, v45, v39
    v_mul_f32 v68, v49, v68
    v_mfma_f32_16x16x32_bf16 v[28:31], v[8:11], v[24:27], v[28:31]
    s_waitcnt vmcnt(20) lgkmcnt(4)
    v_mul_f32 v69, v49, v69
    v_mul_f32 v70, v49, v70
    v_mfma_f32_16x16x32_bf16 v[156:159], v[12:15], a[220:223], v[156:159]
    s_barrier
    ds_read_b64_tr_b16 v[8:9], v1 offset:49152
    ds_read_b64_tr_b16 v[10:11], v1 offset:50176
    v_mfma_f32_16x16x32_bf16 v[152:155], v[12:15], a[216:219], v[152:155]
    s_add_u32 m0, s41, 32768
    s_mul_i32 s39, s33, 1536
    v_mul_f32 v71, v49, v71
    v_mfma_f32_16x16x32_bf16 v[148:151], v[12:15], a[212:215], v[148:151]
    s_add_u32 s39, s39, s43
    v_cvt_pk_bf16_f32 v66, v68, v69
    v_cvt_pk_bf16_f32 v67, v70, v71
    v_mfma_f32_16x16x32_bf16 v[144:147], v[12:15], a[208:211], v[144:147]
    buffer_load_dwordx4 v60, s[12:15], s39 offen offset:0 lds
    v_mfma_f32_16x16x32_bf16 v[32:35], v[12:15], v[24:27], v[32:35]
    s_waitcnt lgkmcnt(4)
    s_add_u32 s39, s39, 11264
    v_fmac_f32 v72, v46, v36
    v_mfma_f32_16x16x32_bf16 v[160:163], v[16:19], a[208:211], v[160:163]
    ds_read_b64_tr_b16 v[12:13], v1 offset:57344
    ds_read_b64_tr_b16 v[14:15], v1 offset:58368
    v_mfma_f32_16x16x32_bf16 v[164:167], v[16:19], a[212:215], v[164:167]
    buffer_load_dwordx4 v[56:59], v61, s[16:19], 0 offen sc1
    v_mfma_f32_16x16x32_bf16 v[168:171], v[16:19], a[216:219], v[168:171]
    buffer_store_dwordx4 v[64:67], v62, s[20:23], s52 offen sc1
    v_fmac_f32 v73, v46, v37
    v_fmac_f32 v74, v46, v38
    v_fmac_f32 v75, v46, v39
    v_mfma_f32_16x16x32_bf16 v[172:175], v[16:19], a[220:223], v[172:175]
    s_waitcnt lgkmcnt(4)
    v_mul_f32 v72, v50, v72
    v_mul_f32 v73, v50, v73
    v_mfma_f32_16x16x32_bf16 v[188:191], v[20:23], a[220:223], v[188:191]
    ds_read_b64_tr_b16 v[16:17], v2 offset:49152
    ds_read_b64_tr_b16 v[18:19], v2 offset:50176
    v_mfma_f32_16x16x32_bf16 v[184:187], v[20:23], a[216:219], v[184:187]
    buffer_load_dwordx4 v60, s[12:15], s39 offen offset:1024 lds
    v_mfma_f32_16x16x32_bf16 v[180:183], v[20:23], a[212:215], v[180:183]
    s_add_u32 s39, s39, 35840
    v_mul_f32 v74, v50, v74
    v_mul_f32 v75, v50, v75
    v_mfma_f32_16x16x32_bf16 v[176:179], v[20:23], a[208:211], v[176:179]
    s_waitcnt lgkmcnt(4)
    v_cvt_pk_bf16_f32 v72, v72, v73
    v_cvt_pk_bf16_f32 v73, v74, v75
    v_mfma_f32_16x16x32_bf16 v[128:131], v[8:11], a[224:227], v[128:131]
    ds_read_b64_tr_b16 v[20:21], v2 offset:57344
    ds_read_b64_tr_b16 v[22:23], v2 offset:58368
    v_mfma_f32_16x16x32_bf16 v[132:135], v[8:11], a[228:231], v[132:135]
    v_fmac_f32 v76, v47, v36
    v_fmac_f32 v77, v47, v37
    v_mfma_f32_16x16x32_bf16 v[136:139], v[8:11], a[232:235], v[136:139]
    v_fmac_f32 v78, v47, v38
    v_fmac_f32 v79, v47, v39
    v_mfma_f32_16x16x32_bf16 v[140:143], v[8:11], a[236:239], v[140:143]
    buffer_load_dwordx4 v60, s[12:15], s39 offen offset:2048 lds
    v_mfma_f32_16x16x32_bf16 v[28:31], v[8:11], v[24:27], v[28:31]
    s_waitcnt lgkmcnt(4)
    s_add_u32 s39, s39, 11264
    v_mul_f32 v76, v51, v76
    v_mfma_f32_16x16x32_bf16 v[156:159], v[12:15], a[236:239], v[156:159]
    ds_read_b64_tr_b16 v[8:9], v1 offset:53248
    ds_read_b64_tr_b16 v[10:11], v1 offset:54272
    v_mfma_f32_16x16x32_bf16 v[152:155], v[12:15], a[232:235], v[152:155]
    v_mul_f32 v77, v51, v77
    v_mul_f32 v78, v51, v78
    v_mfma_f32_16x16x32_bf16 v[148:151], v[12:15], a[228:231], v[148:151]
    v_mul_f32 v79, v51, v79
    v_cvt_pk_bf16_f32 v74, v76, v77
    v_mfma_f32_16x16x32_bf16 v[144:147], v[12:15], a[224:227], v[144:147]
    v_cvt_pk_bf16_f32 v75, v78, v79
    v_fmac_f32 v80, v44, v40
    v_mfma_f32_16x16x32_bf16 v[32:35], v[12:15], v[24:27], v[32:35]
    s_waitcnt lgkmcnt(4)
    buffer_load_dwordx4 v60, s[12:15], s39 offen offset:3072 lds
    v_mfma_f32_16x16x32_bf16 v[160:163], v[16:19], a[224:227], v[160:163]
    ds_read_b64_tr_b16 v[12:13], v1 offset:61440
    ds_read_b64_tr_b16 v[14:15], v1 offset:62464
    v_mfma_f32_16x16x32_bf16 v[164:167], v[16:19], a[228:231], v[164:167]
    buffer_store_dwordx4 v[72:75], v62, s[20:23], s54 offen sc1
    v_fmac_f32 v81, v44, v41
    v_fmac_f32 v82, v44, v42
    v_fmac_f32 v83, v44, v43
    v_mfma_f32_16x16x32_bf16 v[168:171], v[16:19], a[232:235], v[168:171]
    v_mul_f32 v80, v48, v80
    v_mul_f32 v81, v48, v81
    v_mfma_f32_16x16x32_bf16 v[172:175], v[16:19], a[236:239], v[172:175]
    s_waitcnt lgkmcnt(4)
    v_mul_f32 v82, v48, v82
    v_mul_f32 v83, v48, v83
    v_mfma_f32_16x16x32_bf16 v[188:191], v[20:23], a[236:239], v[188:191]
    ds_read_b64_tr_b16 v[16:17], v2 offset:53248
    ds_read_b64_tr_b16 v[18:19], v2 offset:54272
    v_mfma_f32_16x16x32_bf16 v[184:187], v[20:23], a[232:235], v[184:187]
    v_cvt_pk_bf16_f32 v80, v80, v81
    v_cvt_pk_bf16_f32 v81, v82, v83
    v_mfma_f32_16x16x32_bf16 v[180:183], v[20:23], a[228:231], v[180:183]
    ds_read_b128 v[68:71], v63 offset:0
    v_fmac_f32 v84, v45, v40
    v_mfma_f32_16x16x32_bf16 v[176:179], v[20:23], a[224:227], v[176:179]
    s_waitcnt lgkmcnt(5)
    ds_read_b128 v[76:79], v63 offset:256
    v_fmac_f32 v85, v45, v41
    v_mfma_f32_16x16x32_bf16 v[128:131], v[8:11], a[240:243], v[128:131]
    ds_read_b64_tr_b16 v[20:21], v2 offset:61440
    ds_read_b64_tr_b16 v[22:23], v2 offset:62464
    v_mfma_f32_16x16x32_bf16 v[132:135], v[8:11], a[244:247], v[132:135]
    v_fmac_f32 v86, v45, v42
    v_fmac_f32 v87, v45, v43
    v_mfma_f32_16x16x32_bf16 v[136:139], v[8:11], a[248:251], v[136:139]
    s_add_u32 s52, s52, 4096
    v_mul_f32 v84, v49, v84
    v_mul_f32 v85, v49, v85
    v_mfma_f32_16x16x32_bf16 v[140:143], v[8:11], a[252:255], v[140:143]
    v_mul_f32 v86, v49, v86
    v_mul_f32 v87, v49, v87
    v_mfma_f32_16x16x32_bf16 v[28:31], v[8:11], v[24:27], v[28:31]
    s_waitcnt vmcnt(23) lgkmcnt(6)
    v_add_u32 v1, 4294934528, v1
    v_cvt_pk_bf16_f32 v82, v84, v85
    v_mfma_f32_16x16x32_bf16 v[156:159], v[12:15], a[252:255], v[156:159]
    s_barrier
    ds_read_b64_tr_b16 v[8:9], v1 offset:0
    ds_read_b64_tr_b16 v[10:11], v1 offset:1024
    v_mfma_f32_16x16x32_bf16 v[152:155], v[12:15], a[248:251], v[152:155]
    v_cvt_pk_bf16_f32 v83, v86, v87
    v_fmac_f32 v88, v46, v40
    v_mfma_f32_16x16x32_bf16 v[148:151], v[12:15], a[244:247], v[148:151]
    buffer_store_dwordx4 v[80:83], v62, s[20:23], s52 offen sc1
    v_fmac_f32 v89, v46, v41
    v_fmac_f32 v90, v46, v42
    v_fmac_f32 v91, v46, v43
    v_mfma_f32_16x16x32_bf16 v[144:147], v[12:15], a[240:243], v[144:147]
    v_mul_f32 v88, v50, v88
    v_mul_f32 v89, v50, v89
    v_mfma_f32_16x16x32_bf16 v[32:35], v[12:15], v[24:27], v[32:35]
    s_waitcnt lgkmcnt(6)
    v_mul_f32 v90, v50, v90
    v_mul_f32 v91, v50, v91
    v_mfma_f32_16x16x32_bf16 v[160:163], v[16:19], a[240:243], v[160:163]
    ds_read_b64_tr_b16 v[12:13], v1 offset:8192
    ds_read_b64_tr_b16 v[14:15], v1 offset:9216
    v_mfma_f32_16x16x32_bf16 v[164:167], v[16:19], a[244:247], v[164:167]
    v_cvt_pk_bf16_f32 v88, v88, v89
    v_cvt_pk_bf16_f32 v89, v90, v91
    v_mfma_f32_16x16x32_bf16 v[168:171], v[16:19], a[248:251], v[168:171]
    v_fmac_f32 v92, v47, v40
    v_fmac_f32 v93, v47, v41
    v_mfma_f32_16x16x32_bf16 v[172:175], v[16:19], a[252:255], v[172:175]
    s_waitcnt lgkmcnt(4)
    v_fmac_f32 v94, v47, v42
    v_fmac_f32 v95, v47, v43
    v_mfma_f32_16x16x32_bf16 v[188:191], v[20:23], a[252:255], v[188:191]
    ds_read_b64_tr_b16 v[16:17], v1 offset:4096
    ds_read_b64_tr_b16 v[18:19], v1 offset:5120
    v_mfma_f32_16x16x32_bf16 v[184:187], v[20:23], a[248:251], v[184:187]
    s_add_u32 s54, s54, 4096
    v_mul_f32 v92, v51, v92
    v_mul_f32 v93, v51, v93
    v_mfma_f32_16x16x32_bf16 v[180:183], v[20:23], a[244:247], v[180:183]
    v_mul_f32 v94, v51, v94
    v_mul_f32 v95, v51, v95
    v_mfma_f32_16x16x32_bf16 v[176:179], v[20:23], a[240:243], v[176:179]
    s_waitcnt lgkmcnt(4)
    v_cvt_pk_bf16_f32 v90, v92, v93
    v_cvt_pk_bf16_f32 v91, v94, v95
    v_mfma_f32_16x16x32_bf16 v[128:131], v[8:11], a[0:3], v[128:131]
    ds_read_b64_tr_b16 v[20:21], v1 offset:12288
    ds_read_b64_tr_b16 v[22:23], v1 offset:13312
    v_mfma_f32_16x16x32_bf16 v[132:135], v[8:11], a[4:7], v[132:135]
    buffer_store_dwordx4 v[88:91], v62, s[20:23], s54 offen sc1
    v_mfma_f32_16x16x32_bf16 v[136:139], v[8:11], a[8:11], v[136:139]
    v_fmac_f32 v96, v44, v68
    v_fmac_f32 v97, v44, v69
    v_mfma_f32_16x16x32_bf16 v[140:143], v[8:11], a[12:15], v[140:143]
    v_fmac_f32 v98, v44, v70
    v_fmac_f32 v99, v44, v71
    v_mfma_f32_16x16x32_bf16 v[28:31], v[8:11], v[24:27], v[28:31]
    s_waitcnt vmcnt(21) lgkmcnt(4)
    v_add_u32 v1, 98304, v1
    v_mul_f32 v96, v48, v96
    v_mfma_f32_16x16x32_bf16 v[156:159], v[12:15], a[12:15], v[156:159]
    s_barrier
    ds_read_b64_tr_b16 v[8:9], v1 offset:0
    ds_read_b64_tr_b16 v[10:11], v1 offset:1024
    v_mfma_f32_16x16x32_bf16 v[152:155], v[12:15], a[8:11], v[152:155]
    v_mul_f32 v97, v48, v97
    v_mul_f32 v98, v48, v98
    v_mfma_f32_16x16x32_bf16 v[148:151], v[12:15], a[4:7], v[148:151]
    v_mul_f32 v99, v48, v99
    v_cvt_pk_bf16_f32 v96, v96, v97
    v_mfma_f32_16x16x32_bf16 v[144:147], v[12:15], a[0:3], v[144:147]
    v_cvt_pk_bf16_f32 v97, v98, v99
    v_fmac_f32 v100, v45, v68
    v_mfma_f32_16x16x32_bf16 v[32:35], v[12:15], v[24:27], v[32:35]
    s_waitcnt lgkmcnt(4)
    v_fmac_f32 v101, v45, v69
    v_fmac_f32 v102, v45, v70
    v_mfma_f32_16x16x32_bf16 v[128:131], v[16:19], a[16:19], v[128:131]
    ds_read_b64_tr_b16 v[12:13], v1 offset:8192
    ds_read_b64_tr_b16 v[14:15], v1 offset:9216
    v_mfma_f32_16x16x32_bf16 v[132:135], v[16:19], a[20:23], v[132:135]
    v_fmac_f32 v103, v45, v71
    v_mul_f32 v100, v49, v100
    v_mfma_f32_16x16x32_bf16 v[136:139], v[16:19], a[24:27], v[136:139]
    v_mul_f32 v101, v49, v101
    v_mul_f32 v102, v49, v102
    v_mfma_f32_16x16x32_bf16 v[140:143], v[16:19], a[28:31], v[140:143]
    v_mul_f32 v103, v49, v103
    v_cvt_pk_bf16_f32 v98, v100, v101
    v_mfma_f32_16x16x32_bf16 v[28:31], v[16:19], v[24:27], v[28:31]
    s_waitcnt lgkmcnt(4)
    v_cvt_pk_bf16_f32 v99, v102, v103
    v_fmac_f32 v104, v46, v68
    v_mfma_f32_16x16x32_bf16 v[156:159], v[20:23], a[28:31], v[156:159]
    ds_read_b64_tr_b16 v[16:17], v1 offset:4096
    ds_read_b64_tr_b16 v[18:19], v1 offset:5120
    v_mfma_f32_16x16x32_bf16 v[152:155], v[20:23], a[24:27], v[152:155]
    buffer_store_dwordx4 v[96:99], v62, s[20:23], s53 offen sc1
    v_fmac_f32 v105, v46, v69
    v_fmac_f32 v106, v46, v70
    v_fmac_f32 v107, v46, v71
    v_mfma_f32_16x16x32_bf16 v[148:151], v[20:23], a[20:23], v[148:151]
    s_waitcnt vmcnt(8)
    v_min3_u32 v56, v56, v57, v58
    v_min_u32 v56, v56, v59
    v_mfma_f32_16x16x32_bf16 v[144:147], v[20:23], a[16:19], v[144:147]
    v_cmp_gt_u32 vcc, 1, v56
    v_mul_f32 v104, v50, v104
    v_mfma_f32_16x16x32_bf16 v[32:35], v[20:23], v[24:27], v[32:35]
    s_cbranch_vccnz K_slow0
K_back0:
    v_mul_f32 v105, v50, v105
    s_waitcnt lgkmcnt(4)
    v_mfma_f32_16x16x32_bf16 v[128:131], v[8:11], a[32:35], v[128:131]
    s_lshl_b32 s0, s3, 1
    ds_read_b64_tr_b16 v[20:21], v1 offset:12288
    ds_read_b64_tr_b16 v[22:23], v1 offset:13312
    v_mfma_f32_16x16x32_bf16 v[132:135], v[8:11], a[36:39], v[132:135]
    s_add_u32 s0, s0, s47
    s_mul_i32 s0, s0, 40
    v_bfe_u32 v56, v0, 2, 1
    v_mfma_f32_16x16x32_bf16 v[136:139], v[8:11], a[40:43], v[136:139]
    v_mad_u32_u24 v56, v56, 39, s0
    v_and_b32 v56, 0x380, v56
    v_mfma_f32_16x16x32_bf16 v[140:143], v[8:11], a[44:47], v[140:143]
    v_bfe_u32 v61, v0, 3, 2
    v_min_u32 v61, 2, v61
    v_mfma_f32_16x16x32_bf16 v[28:31], v[8:11], v[24:27], v[28:31]
    s_waitcnt lgkmcnt(4)
    v_add_u32 v1, 4294885376, v1
    v_mul_u32_u24 v61, 640, v61
    v_mfma_f32_16x16x32_bf16 v[156:159], v[12:15], a[44:47], v[156:159]
    s_barrier
    ds_read_b64_tr_b16 v[8:9], v1 offset:0
    ds_read_b64_tr_b16 v[10:11], v1 offset:1024
    v_mfma_f32_16x16x32_bf16 v[152:155], v[12:15], a[40:43], v[152:155]
    s_add_u32 m0, s41, 65536
    s_add_u32 s39, s34, s44
    v_add_u32 v61, v61, v56
    v_mfma_f32_16x16x32_bf16 v[148:151], v[12:15], a[36:39], v[148:151]
    buffer_load_dwordx4 v62, s[16:19], s39 offen offset:0 sc1 lds
    v_mfma_f32_16x16x32_bf16 v[144:147], v[12:15], a[32:35], v[144:147]
    v_lshrrev_b32 v56, 5, v0
    v_mad_u32_u24 v61, v56, s81, v61
    v_mfma_f32_16x16x32_bf16 v[32:35], v[12:15], v[24:27], v[32:35]
    s_waitcnt lgkmcnt(4)
    v_mul_f32 v106, v50, v106
    v_mul_f32 v107, v50, v107
    v_mfma_f32_16x16x32_bf16 v[128:131], v[16:19], a[48:51], v[128:131]
    ds_read_b64_tr_b16 v[12:13], v1 offset:8192
    ds_read_b64_tr_b16 v[14:15], v1 offset:9216
    v_mfma_f32_16x16x32_bf16 v[132:135], v[16:19], a[52:55], v[132:135]
    v_cvt_pk_bf16_f32 v104, v104, v105
    v_cvt_pk_bf16_f32 v105, v106, v107
    v_mfma_f32_16x16x32_bf16 v[136:139], v[16:19], a[56:59], v[136:139]
    buffer_load_dwordx4 v62, s[16:19], s39 offen offset:1024 sc1 lds
    v_mfma_f32_16x16x32_bf16 v[140:143], v[16:19], a[60:63], v[140:143]
    s_addk_i32 s39, 30720
    v_fmac_f32 v108, v47, v68
    v_fmac_f32 v109, v47, v69
    v_mfma_f32_16x16x32_bf16 v[28:31], v[16:19], v[24:27], v[28:31]
    s_waitcnt lgkmcnt(4)
    v_fmac_f32 v110, v47, v70
    v_fmac_f32 v111, v47, v71
    v_mfma_f32_16x16x32_bf16 v[156:159], v[20:23], a[60:63], v[156:159]
    ds_read_b64_tr_b16 v[16:17], v1 offset:4096
    ds_read_b64_tr_b16 v[18:19], v1 offset:5120
    v_mfma_f32_16x16x32_bf16 v[152:155], v[20:23], a[56:59], v[152:155]
    v_mul_f32 v108, v51, v108
    v_mul_f32 v109, v51, v109
    v_mfma_f32_16x16x32_bf16 v[148:151], v[20:23], a[52:55], v[148:151]
    buffer_load_dwordx4 v62, s[16:19], s39 offen offset:2048 sc1 lds
    v_mfma_f32_16x16x32_bf16 v[144:147], v[20:23], a[48:51], v[144:147]
    v_mul_f32 v110, v51, v110
    v_mul_f32 v111, v51, v111
    v_mfma_f32_16x16x32_bf16 v[32:35], v[20:23], v[24:27], v[32:35]
    s_waitcnt lgkmcnt(4)
    v_cvt_pk_bf16_f32 v106, v108, v109
    v_cvt_pk_bf16_f32 v107, v110, v111
    v_mfma_f32_16x16x32_bf16 v[128:131], v[8:11], a[64:67], v[128:131]
    ds_read_b64_tr_b16 v[20:21], v1 offset:12288
    ds_read_b64_tr_b16 v[22:23], v1 offset:13312
    v_mfma_f32_16x16x32_bf16 v[132:135], v[8:11], a[68:71], v[132:135]
    buffer_store_dwordx4 v[104:107], v62, s[20:23], s55 offen sc1
    v_fmac_f32 v112, v44, v76
    v_fmac_f32 v113, v44, v77
    v_fmac_f32 v114, v44, v78
    v_mfma_f32_16x16x32_bf16 v[136:139], v[8:11], a[72:75], v[136:139]
    buffer_load_dwordx4 v62, s[16:19], s39 offen offset:3072 sc1 lds
    v_mfma_f32_16x16x32_bf16 v[140:143], v[8:11], a[76:79], v[140:143]
    v_fmac_f32 v115, v44, v79
    v_mul_f32 v112, v48, v112
    v_mfma_f32_16x16x32_bf16 v[28:31], v[8:11], v[24:27], v[28:31]
    s_waitcnt lgkmcnt(4)
    v_add_u32 v1, 98304, v1
    v_mul_f32 v113, v48, v113
    v_mfma_f32_16x16x32_bf16 v[156:159], v[12:15], a[76:79], v[156:159]
    s_barrier
    ds_read_b64_tr_b16 v[8:9], v1 offset:0
    ds_read_b64_tr_b16 v[10:11], v1 offset:1024
    v_mfma_f32_16x16x32_bf16 v[152:155], v[12:15], a[72:75], v[152:155]
    s_add_u32 m0, s41, 49152
    s_add_u32 s39, s35, s44
    v_mul_f32 v114, v48, v114
    v_mfma_f32_16x16x32_bf16 v[148:151], v[12:15], a[68:71], v[148:151]
    buffer_load_dwordx4 v62, s[16:19], s39 offen offset:0 sc1 lds
    v_mfma_f32_16x16x32_bf16 v[144:147], v[12:15], a[64:67], v[144:147]
    v_mul_f32 v115, v48, v115
    v_cvt_pk_bf16_f32 v112, v112, v113
    v_mfma_f32_16x16x32_bf16 v[32:35], v[12:15], v[24:27], v[32:35]
    s_waitcnt lgkmcnt(4)
    v_cvt_pk_bf16_f32 v113, v114, v115
    v_fmac_f32 v116, v45, v76
    v_mfma_f32_16x16x32_bf16 v[128:131], v[16:19], a[80:83], v[128:131]
    ds_read_b64_tr_b16 v[12:13], v1 offset:8192
    ds_read_b64_tr_b16 v[14:15], v1 offset:9216
    v_mfma_f32_16x16x32_bf16 v[132:135], v[16:19], a[84:87], v[132:135]
    v_fmac_f32 v117, v45, v77
    v_fmac_f32 v118, v45, v78
    v_mfma_f32_16x16x32_bf16 v[136:139], v[16:19], a[88:91], v[136:139]
    buffer_load_dwordx4 v62, s[16:19], s39 offen offset:1024 sc1 lds
    v_mfma_f32_16x16x32_bf16 v[140:143], v[16:19], a[92:95], v[140:143]
    s_add_u32 s39, s39, 30720
    v_fmac_f32 v119, v45, v79
    v_mul_f32 v116, v49, v116
    v_mfma_f32_16x16x32_bf16 v[28:31], v[16:19], v[24:27], v[28:31]
    s_waitcnt lgkmcnt(4)
    s_add_u32 s53, s53, 4096
    v_mul_f32 v117, v49, v117
    v_mfma_f32_16x16x32_bf16 v[156:159], v[20:23], a[92:95], v[156:159]
    ds_read_b64_tr_b16 v[16:17], v1 offset:4096
    ds_read_b64_tr_b16 v[18:19], v1 offset:5120
    v_mfma_f32_16x16x32_bf16 v[152:155], v[20:23], a[88:91], v[152:155]
    v_mul_f32 v118, v49, v118
    v_mul_f32 v119, v49, v119
    v_mfma_f32_16x16x32_bf16 v[148:151], v[20:23], a[84:87], v[148:151]
    buffer_load_dwordx4 v62, s[16:19], s39 offen offset:2048 sc1 lds
    v_mfma_f32_16x16x32_bf16 v[144:147], v[20:23], a[80:83], v[144:147]
    v_cvt_pk_bf16_f32 v114, v116, v117
    v_cvt_pk_bf16_f32 v115, v118, v119
    v_mfma_f32_16x16x32_bf16 v[32:35], v[20:23], v[24:27], v[32:35]
    s_waitcnt lgkmcnt(4)
    buffer_store_dwordx4 v[112:115], v62, s[20:23], s53 offen sc1
    v_fmac_f32 v120, v46, v76
    v_fmac_f32 v121, v46, v77
    v_fmac_f32 v122, v46, v78
    v_mfma_f32_16x16x32_bf16 v[128:131], v[8:11], a[96:99], v[128:131]
    ds_read_b64_tr_b16 v[20:21], v1 offset:12288
    ds_read_b64_tr_b16 v[22:23], v1 offset:13312
    v_mfma_f32_16x16x32_bf16 v[132:135], v[8:11], a[100:103], v[132:135]
    v_fmac_f32 v123, v46, v79
    v_mul_f32 v120, v50, v120
    v_mfma_f32_16x16x32_bf16 v[136:139], v[8:11], a[104:107], v[136:139]
    buffer_load_dwordx4 v62, s[16:19], s39 offen offset:3072 sc1 lds
    v_mfma_f32_16x16x32_bf16 v[140:143], v[8:11], a[108:111], v[140:143]
    v_mul_f32 v121, v50, v121
    v_mul_f32 v122, v50, v122
    v_mfma_f32_16x16x32_bf16 v[28:31], v[8:11], v[24:27], v[28:31]
    s_waitcnt lgkmcnt(4)
    v_mul_f32 v123, v50, v123
    v_cvt_pk_bf16_f32 v120, v120, v121
    v_mfma_f32_16x16x32_bf16 v[156:159], v[12:15], a[108:111], v[156:159]
    s_barrier
    ds_read_b64_tr_b16 v[8:9], v1 offset:16384
    ds_read_b64_tr_b16 v[10:11], v1 offset:17408
    v_mfma_f32_16x16x32_bf16 v[152:155], v[12:15], a[104:107], v[152:155]
    s_add_u32 m0, s41, 81920
    s_add_u32 s39, s36, s44
    v_cvt_pk_bf16_f32 v121, v122, v123
    v_mfma_f32_16x16x32_bf16 v[148:151], v[12:15], a[100:103], v[148:151]
    buffer_load_dwordx4 v62, s[16:19], s39 offen offset:0 sc1 lds
    v_mfma_f32_16x16x32_bf16 v[144:147], v[12:15], a[96:99], v[144:147]
    v_fmac_f32 v124, v47, v76
    v_fmac_f32 v125, v47, v77
    v_mfma_f32_16x16x32_bf16 v[32:35], v[12:15], v[24:27], v[32:35]
    s_waitcnt lgkmcnt(4)
    v_fmac_f32 v126, v47, v78
    v_fmac_f32 v127, v47, v79
    v_mfma_f32_16x16x32_bf16 v[128:131], v[16:19], a[112:115], v[128:131]
    ds_read_b64_tr_b16 v[12:13], v1 offset:24576
    ds_read_b64_tr_b16 v[14:15], v1 offset:25600
    v_mfma_f32_16x16x32_bf16 v[132:135], v[16:19], a[116:119], v[132:135]
    s_add_u32 s55, s55, 4096
    v_mul_f32 v124, v51, v124
    v_mul_f32 v125, v51, v125
    v_mfma_f32_16x16x32_bf16 v[136:139], v[16:19], a[120:123], v[136:139]
    buffer_load_dwordx4 v62, s[16:19], s39 offen offset:1024 sc1 lds
    v_mfma_f32_16x16x32_bf16 v[140:143], v[16:19], a[124:127], v[140:143]
    s_add_u32 s39, s39, 30720
    v_mul_f32 v126, v51, v126
    v_mul_f32 v127, v51, v127
    v_mfma_f32_16x16x32_bf16 v[28:31], v[16:19], v[24:27], v[28:31]
    s_waitcnt lgkmcnt(4)
    s_xor_b32 s80, s75, 0
    v_cvt_pk_bf16_f32 v122, v124, v125
    v_mfma_f32_16x16x32_bf16 v[156:159], v[20:23], a[124:127], v[156:159]
    s_mul_i32 s80, s80, 40960
    ds_read_b64_tr_b16 v[16:17], v1 offset:20480
    ds_read_b64_tr_b16 v[18:19], v1 offset:21504
    v_mfma_f32_16x16x32_bf16 v[152:155], v[20:23], a[120:123], v[152:155]
    s_add_u32 s80, s80, s73
    v_cvt_pk_bf16_f32 v123, v126, v127
    v_mul_f32 v48, s58, v48
    v_mfma_f32_16x16x32_bf16 v[148:151], v[20:23], a[116:119], v[148:151]
    buffer_load_dwordx4 v62, s[16:19], s39 offen offset:2048 sc1 lds
    v_mfma_f32_16x16x32_bf16 v[144:147], v[20:23], a[112:115], v[144:147]
    buffer_store_dwordx4 v[120:123], v62, s[20:23], s55 offen sc1
    v_mul_f32 v49, s58, v49
    v_mul_f32 v50, s58, v50
    v_mul_f32 v51, s58, v51
    v_mfma_f32_16x16x32_bf16 v[32:35], v[20:23], v[24:27], v[32:35]
    s_waitcnt lgkmcnt(4)
    v_lshrrev_b32 v119, 4, v0
    v_and_b32 v124, 1, v119
    v_mfma_f32_16x16x32_bf16 v[128:131], v[8:11], a[128:131], v[128:131]
    s_mov_b32 s24, 0x55505555
    ds_read_b64_tr_b16 v[20:21], v1 offset:28672
    ds_read_b64_tr_b16 v[22:23], v1 offset:29696
    v_mfma_f32_16x16x32_bf16 v[132:135], v[8:11], a[132:135], v[132:135]
    s_mov_b32 s25, 0x50005500
    v_mul_u32_u24 v118, 1280, v124
    v_and_b32 v117, 0xf0, v62
    v_mfma_f32_16x16x32_bf16 v[136:139], v[8:11], a[136:139], v[136:139]
    buffer_load_dwordx4 v62, s[16:19], s39 offen offset:3072 sc1 lds
    v_mfma_f32_16x16x32_bf16 v[140:143], v[8:11], a[140:143], v[140:143]
    s_mov_b32 s26, 0xaaa0aaaa
    v_add_u32 v117, v117, v118
    v_xor_b32 v60, 2, v119
    v_mfma_f32_16x16x32_bf16 v[28:31], v[8:11], v[24:27], v[28:31]
    s_waitcnt vmcnt(19) lgkmcnt(4)
    v_add_u32 v1, 4294885376, v1
    v_min_u32 v118, 1, v60
    v_mfma_f32_16x16x32_bf16 v[156:159], v[12:15], a[140:143], v[156:159]
    s_barrier
    ds_read_b64_tr_b16 v[8:9], v1 offset:0
    ds_read_b64_tr_b16 v[10:11], v1 offset:1024
    v_mfma_f32_16x16x32_bf16 v[152:155], v[12:15], a[136:139], v[152:155]
    s_mov_b32 s27, 0xa000aa00
    v_lshl_add_u32 v118, v118, 31, v117
    v_lshrrev_b32 v119, 1, v60
    v_mfma_f32_16x16x32_bf16 v[148:151], v[12:15], a[132:135], v[148:151]
    s_mov_b32 s28, 0x50000
    v_sub_u32 v124, 41, v124
    v_mad_u32_u24 v124, v124, v119, 40
    v_mfma_f32_16x16x32_bf16 v[144:147], v[12:15], a[128:131], v[144:147]
    s_mov_b32 s29, 0x5550055
    v_xor_b32 v60, 1, v60
    v_min_u32 v60, 1, v60
    v_mfma_f32_16x16x32_bf16 v[32:35], v[12:15], v[24:27], v[32:35]
    s_waitcnt lgkmcnt(4)
    v_lshl_add_u32 v60, v60, 31, v117
    v_lshl_add_u32 v117, v124, 10, v117
    v_mfma_f32_16x16x32_bf16 v[128:131], v[16:19], a[144:147], v[128:131]
    s_mov_b32 s30, 0xa0000
    ds_read_b64_tr_b16 v[12:13], v1 offset:8192
    ds_read_b64_tr_b16 v[14:15], v1 offset:9216
    v_mfma_f32_16x16x32_bf16 v[132:135], v[16:19], a[148:151], v[132:135]
    s_mov_b32 s31, 0xaaa00aa
    v_mov_b32 v116, 1
    v_lshrrev_b32 v126, 4, v0
    v_mfma_f32_16x16x32_bf16 v[136:139], v[16:19], a[152:155], v[136:139]
    s_mov_b32 s32, 0xfff0ffff
    v_lshlrev_b32 v126, 7, v126
    v_add_u32 v119, 4096, v62
    v_mfma_f32_16x16x32_bf16 v[140:143], v[16:19], a[156:159], v[140:143]
    buffer_load_dwordx4 v[96:99], v62, s[16:19], s80 offen offset:0 sc1
    v_mfma_f32_16x16x32_bf16 v[28:31], v[16:19], v[24:27], v[28:31]
    s_waitcnt lgkmcnt(4)
    v_mfma_f32_16x16x32_bf16 v[156:159], v[20:23], a[156:159], v[156:159]
    s_mov_b32 s33, 0xf000ff00
    ds_read_b64_tr_b16 v[16:17], v1 offset:4096
    ds_read_b64_tr_b16 v[18:19], v1 offset:5120
    v_mfma_f32_16x16x32_bf16 v[152:155], v[20:23], a[152:155], v[152:155]
    s_mov_b32 s12, 0x55405554
    v_mfma_f32_16x16x32_bf16 v[148:151], v[20:23], a[148:151], v[148:151]
    buffer_load_dwordx4 v[100:103], v62, s[16:19], s80 offen offset:1024 sc1
    v_mfma_f32_16x16x32_bf16 v[144:147], v[20:23], a[144:147], v[144:147]
    s_mov_b32 s13, 0x40005400
    v_mfma_f32_16x16x32_bf16 v[32:35], v[20:23], v[24:27], v[32:35]
    s_waitcnt lgkmcnt(4)
    v_mfma_f32_16x16x32_bf16 v[128:131], v[8:11], a[160:163], v[128:131]
    s_mov_b32 s14, 0xaa80aaa8
    ds_read_b64_tr_b16 v[20:21], v1 offset:12288
    ds_read_b64_tr_b16 v[22:23], v1 offset:13312
    v_mfma_f32_16x16x32_bf16 v[132:135], v[8:11], a[164:167], v[132:135]
    buffer_load_dwordx4 v[104:107], v62, s[16:19], s80 offen offset:2048 sc1
    v_mfma_f32_16x16x32_bf16 v[136:139], v[8:11], a[168:171], v[136:139]
    s_mov_b32 s15, 0x8000a800
    v_mfma_f32_16x16x32_bf16 v[140:143], v[8:11], a[172:175], v[140:143]
    s_mov_b32 s20, 0x150001
    v_mfma_f32_16x16x32_bf16 v[28:31], v[8:11], v[24:27], v[28:31]
    s_waitcnt lgkmcnt(4)
    v_add_u32 v2, 4294934528, v2
    v_mfma_f32_16x16x32_bf16 v[156:159], v[12:15], a[172:175], v[156:159]
    s_mov_b32 s21, 0x15550155
    ds_read_b64_tr_b16 v[8:9], v2 offset:0
    ds_read_b64_tr_b16 v[10:11], v2 offset:1024
    v_mfma_f32_16x16x32_bf16 v[152:155], v[12:15], a[168:171], v[152:155]
    buffer_load_dwordx4 v[108:111], v62, s[16:19], s80 offen offset:3072 sc1
    v_mfma_f32_16x16x32_bf16 v[148:151], v[12:15], a[164:167], v[148:151]
    s_add_u32 s80, s80, 4096
    v_mfma_f32_16x16x32_bf16 v[144:147], v[12:15], a[160:163], v[144:147]
    s_mov_b32 s22, 0x2a0002
    v_mul_u32_u24 v4, 26, v0
    v_lshrrev_b32 v4, 8, v4
    v_mfma_f32_16x16x32_bf16 v[32:35], v[12:15], v[24:27], v[32:35]
    s_waitcnt lgkmcnt(4)
    v_mul_u32_u24 v4, 1120, v4
    v_add3_u32 v4, v4, v62, s68
    v_mfma_f32_16x16x32_bf16 v[128:131], v[16:19], a[176:179], v[128:131]
    s_mul_i32 s39, s46, 3072
    ds_read_b64_tr_b16 v[12:13], v2 offset:8192
    ds_read_b64_tr_b16 v[14:15], v2 offset:9216
    v_mfma_f32_16x16x32_bf16 v[132:135], v[16:19], a[180:183], v[132:135]
    s_add_u32 m0, s39, 147456
    v_mfma_f32_16x16x32_bf16 v[136:139], v[16:19], a[184:187], v[136:139]
    buffer_load_dwordx4 v4, s[4:7], 0 offen offset:0 lds
    v_mfma_f32_16x16x32_bf16 v[140:143], v[16:19], a[188:191], v[140:143]
    s_mov_b32 s23, 0x2aaa02aa
    v_add_u32 v4, 6720, v4
    v_mfma_f32_16x16x32_bf16 v[28:31], v[16:19], v[24:27], v[28:31]
    s_waitcnt lgkmcnt(4)
    buffer_load_dwordx4 v[112:115], v62, s[16:19], s80 offen offset:0 sc1
    v_mfma_f32_16x16x32_bf16 v[156:159], v[20:23], a[188:191], v[156:159]
    s_mov_b32 s52, 0xffc0fffc
    ds_read_b64_tr_b16 v[16:17], v2 offset:4096
    ds_read_b64_tr_b16 v[18:19], v2 offset:5120
    v_mfma_f32_16x16x32_bf16 v[152:155], v[20:23], a[184:187], v[152:155]
    s_mov_b32 s53, 0xc000fc00
    v_mfma_f32_16x16x32_bf16 v[148:151], v[20:23], a[180:183], v[148:151]
    v_mfma_f32_16x16x32_bf16 v[144:147], v[20:23], a[176:179], v[144:147]
    buffer_load_dwordx4 v4, s[4:7], 0 offen offset:960 lds
    v_mfma_f32_16x16x32_bf16 v[32:35], v[20:23], v[24:27], v[32:35]
    s_waitcnt lgkmcnt(4)
    v_add_u32 v4, 4480, v4
    v_mfma_f32_16x16x32_bf16 v[160:163], v[8:11], a[0:3], v[160:163]
    ds_read_b64_tr_b16 v[20:21], v2 offset:12288
    ds_read_b64_tr_b16 v[22:23], v2 offset:13312
    v_mfma_f32_16x16x32_bf16 v[164:167], v[8:11], a[4:7], v[164:167]
    v_mfma_f32_16x16x32_bf16 v[168:171], v[8:11], a[8:11], v[168:171]
    v_mfma_f32_16x16x32_bf16 v[172:175], v[8:11], a[12:15], v[172:175]
    s_waitcnt lgkmcnt(4)
    v_add_u32 v2, 98304, v2
    v_fmac_f32 v128, v44, v28
    v_mfma_f32_16x16x32_bf16 v[188:191], v[12:15], a[12:15], v[188:191]
    ds_read_b64_tr_b16 v[8:9], v2 offset:0
    ds_read_b64_tr_b16 v[10:11], v2 offset:1024
    v_mfma_f32_16x16x32_bf16 v[184:187], v[12:15], a[8:11], v[184:187]
    ds_write_b128 v7, v[28:31] offset:512
    v_mfma_f32_16x16x32_bf16 v[180:183], v[12:15], a[4:7], v[180:183]
    buffer_load_dwordx4 v4, s[4:7], 0 offen offset:1600 lds
    v_mfma_f32_16x16x32_bf16 v[176:179], v[12:15], a[0:3], v[176:179]
    s_waitcnt lgkmcnt(5)
    v_fmac_f32 v129, v44, v29
    v_fmac_f32 v130, v44, v30
    v_mfma_f32_16x16x32_bf16 v[160:163], v[16:19], a[16:19], v[160:163]
    s_add_u32 s69, s69, 65536
    ds_read_b64_tr_b16 v[12:13], v2 offset:8192
    ds_read_b64_tr_b16 v[14:15], v2 offset:9216
    v_mfma_f32_16x16x32_bf16 v[164:167], v[16:19], a[20:23], v[164:167]
    s_waitcnt vmcnt(9)
    buffer_store_byte v116, v5, s[16:19], s69 offen sc1
    v_mfma_f32_16x16x32_bf16 v[168:171], v[16:19], a[24:27], v[168:171]
    s_xor_b32 s49, s75, 4
    v_fmac_f32 v131, v44, v31
    v_fmac_f32 v144, v44, v32
    v_mfma_f32_16x16x32_bf16 v[172:175], v[16:19], a[28:31], v[172:175]
    s_waitcnt lgkmcnt(5)
    ds_write_b128 v7, v[32:35] offset:768
    v_mfma_f32_16x16x32_bf16 v[188:191], v[20:23], a[28:31], v[188:191]
    s_mul_i32 s49, s49, 40960
    ds_read_b64_tr_b16 v[16:17], v2 offset:4096
    ds_read_b64_tr_b16 v[18:19], v2 offset:5120
    v_mfma_f32_16x16x32_bf16 v[184:187], v[20:23], a[24:27], v[184:187]
    s_add_u32 s49, s49, s73
    v_fmac_f32 v145, v44, v33
    v_fmac_f32 v146, v44, v34
    v_mfma_f32_16x16x32_bf16 v[180:183], v[20:23], a[20:23], v[180:183]
    s_xor_b32 s50, s75, 6
    v_fmac_f32 v147, v44, v35
    v_mul_f32 v56, v48, v128
    v_mfma_f32_16x16x32_bf16 v[176:179], v[20:23], a[16:19], v[176:179]
    s_waitcnt lgkmcnt(6)
    v_exp_f32 v56, v56
    v_mfma_f32_16x16x32_bf16 v[160:163], v[8:11], a[32:35], v[160:163]
    s_mul_i32 s50, s50, 40960
    ds_read_b64_tr_b16 v[20:21], v2 offset:12288
    ds_read_b64_tr_b16 v[22:23], v2 offset:13312
    v_mfma_f32_16x16x32_bf16 v[164:167], v[8:11], a[36:39], v[164:167]
    s_add_u32 s50, s50, s73
    v_mul_f32 v57, v48, v129
    v_mul_f32 v58, v48, v130
    v_mfma_f32_16x16x32_bf16 v[168:171], v[8:11], a[40:43], v[168:171]
    s_xor_b32 s43, s75, 1
    v_exp_f32 v57, v57
    v_mfma_f32_16x16x32_bf16 v[172:175], v[8:11], a[44:47], v[172:175]
    s_waitcnt lgkmcnt(5)
    v_add_u32 v2, 4294885376, v2
    v_mul_f32 v59, v48, v131
    v_mfma_f32_16x16x32_bf16 v[188:191], v[12:15], a[44:47], v[188:191]
    s_mul_i32 s43, s43, 40960
    ds_read_b64_tr_b16 v[8:9], v2 offset:0
    ds_read_b64_tr_b16 v[10:11], v2 offset:1024
    v_mfma_f32_16x16x32_bf16 v[184:187], v[12:15], a[40:43], v[184:187]
    s_add_u32 s43, s43, s73
    v_exp_f32 v58, v58
    v_mfma_f32_16x16x32_bf16 v[180:183], v[12:15], a[36:39], v[180:183]
    s_xor_b32 s81, s75, 3
    v_exp_f32 v59, v59
    v_mfma_f32_16x16x32_bf16 v[176:179], v[12:15], a[32:35], v[176:179]
    s_waitcnt lgkmcnt(4)
    v_mul_f32 v128, v128, v144
    v_mul_f32 v129, v129, v145
    v_mfma_f32_16x16x32_bf16 v[160:163], v[16:19], a[48:51], v[160:163]
    s_mul_i32 s81, s81, 40960
    ds_read_b64_tr_b16 v[12:13], v2 offset:8192
    ds_read_b64_tr_b16 v[14:15], v2 offset:9216
    v_mfma_f32_16x16x32_bf16 v[164:167], v[16:19], a[52:55], v[164:167]
    s_add_u32 s81, s81, s73
    v_mul_f32 v130, v130, v146
    v_mul_f32 v131, v131, v147
    v_mfma_f32_16x16x32_bf16 v[168:171], v[16:19], a[56:59], v[168:171]
    s_xor_b32 s54, s75, 5
    v_fma_f32 v144, v56, v52, v52
    v_fma_f32 v145, v57, v52, v52
    v_mfma_f32_16x16x32_bf16 v[172:175], v[16:19], a[60:63], v[172:175]
    s_waitcnt lgkmcnt(4)
    v_rcp_f32 v144, v144
    v_mfma_f32_16x16x32_bf16 v[188:191], v[20:23], a[60:63], v[188:191]
    s_barrier
    ds_read_b64_tr_b16 v[16:17], v2 offset:4096
    ds_read_b64_tr_b16 v[18:19], v2 offset:5120
    v_mfma_f32_16x16x32_bf16 v[184:187], v[20:23], a[56:59], v[184:187]
    s_add_u32 m0, s41, 0
    s_add_u32 s39, s37, s44
    v_fma_f32 v146, v58, v52, v52
    v_mfma_f32_16x16x32_bf16 v[180:183], v[20:23], a[52:55], v[180:183]
    buffer_load_dwordx4 v62, s[16:19], s39 offen offset:0 sc1 lds
    v_mfma_f32_16x16x32_bf16 v[176:179], v[20:23], a[48:51], v[176:179]
    s_waitcnt lgkmcnt(4)
    v_rcp_f32 v145, v145
    v_mfma_f32_16x16x32_bf16 v[160:163], v[8:11], a[64:67], v[160:163]
    s_mul_i32 s54, s54, 40960
    ds_read_b64_tr_b16 v[20:21], v2 offset:12288
    ds_read_b64_tr_b16 v[22:23], v2 offset:13312
    v_mfma_f32_16x16x32_bf16 v[164:167], v[8:11], a[68:71], v[164:167]
    s_add_u32 s54, s54, s73
    v_rcp_f32 v146, v146
    v_mfma_f32_16x16x32_bf16 v[168:171], v[8:11], a[72:75], v[168:171]
    s_xor_b32 s55, s75, 7
    v_fma_f32 v147, v59, v52, v52
    v_mul_f32 v128, v128, v144
    v_mfma_f32_16x16x32_bf16 v[172:175], v[8:11], a[76:79], v[172:175]
    s_waitcnt lgkmcnt(4)
    v_add_u32 v2, 98304, v2
    v_mul_f32 v129, v129, v145
    v_mfma_f32_16x16x32_bf16 v[188:191], v[12:15], a[76:79], v[188:191]
    s_mul_i32 s55, s55, 40960
    ds_read_b64_tr_b16 v[8:9], v2 offset:0
    ds_read_b64_tr_b16 v[10:11], v2 offset:1024
    v_mfma_f32_16x16x32_bf16 v[184:187], v[12:15], a[72:75], v[184:187]
    buffer_load_dwordx4 v62, s[16:19], s39 offen offset:1024 sc1 lds
    v_mfma_f32_16x16x32_bf16 v[180:183], v[12:15], a[68:71], v[180:183]
    s_add_u32 s39, s39, 30720
    v_rcp_f32 v147, v147
    v_mfma_f32_16x16x32_bf16 v[176:179], v[12:15], a[64:67], v[176:179]
    s_waitcnt lgkmcnt(4)
    v_mul_f32 v130, v130, v146
    v_mul_f32 v131, v131, v147
    v_mfma_f32_16x16x32_bf16 v[160:163], v[16:19], a[80:83], v[160:163]
    s_add_u32 s55, s55, s73
    ds_read_b64_tr_b16 v[12:13], v2 offset:8192
    ds_read_b64_tr_b16 v[14:15], v2 offset:9216
    v_mfma_f32_16x16x32_bf16 v[164:167], v[16:19], a[84:87], v[164:167]
    s_xor_b32 s4, s74, 0
    v_cvt_pk_bf16_f32 v128, v128, v129
    v_cvt_pk_bf16_f32 v129, v130, v131
    v_mfma_f32_16x16x32_bf16 v[168:171], v[16:19], a[88:91], v[168:171]
    s_mul_i32 s4, s4, 40960
    v_fmac_f32 v132, v45, v28
    v_fmac_f32 v133, v45, v29
    v_mfma_f32_16x16x32_bf16 v[172:175], v[16:19], a[92:95], v[172:175]
    s_waitcnt lgkmcnt(4)
    buffer_load_dwordx4 v62, s[16:19], s39 offen offset:2048 sc1 lds
    v_mfma_f32_16x16x32_bf16 v[188:191], v[20:23], a[92:95], v[188:191]
    s_add_u32 s4, s4, s73
    ds_read_b64_tr_b16 v[16:17], v2 offset:4096
    ds_read_b64_tr_b16 v[18:19], v2 offset:5120
    v_mfma_f32_16x16x32_bf16 v[184:187], v[20:23], a[88:91], v[184:187]
    s_xor_b32 s5, s74, 1
    v_fmac_f32 v134, v45, v30
    v_fmac_f32 v135, v45, v31
    v_mfma_f32_16x16x32_bf16 v[180:183], v[20:23], a[84:87], v[180:183]
    s_mul_i32 s5, s5, 40960
    v_fmac_f32 v148, v45, v32
    v_fmac_f32 v149, v45, v33
    v_mfma_f32_16x16x32_bf16 v[176:179], v[20:23], a[80:83], v[176:179]
    s_waitcnt lgkmcnt(4)
    v_fmac_f32 v150, v45, v34
    v_fmac_f32 v151, v45, v35
    v_mfma_f32_16x16x32_bf16 v[160:163], v[8:11], a[96:99], v[160:163]
    s_add_u32 s5, s5, s73
    ds_read_b64_tr_b16 v[20:21], v2 offset:12288
    ds_read_b64_tr_b16 v[22:23], v2 offset:13312
    v_mfma_f32_16x16x32_bf16 v[164:167], v[8:11], a[100:103], v[164:167]
    buffer_load_dwordx4 v62, s[16:19], s39 offen offset:3072 sc1 lds
    v_mfma_f32_16x16x32_bf16 v[168:171], v[8:11], a[104:107], v[168:171]
    s_add_u32 m0, s41, 98304
    s_add_u32 s39, s38, s44
    v_mul_f32 v56, v49, v132
    v_mfma_f32_16x16x32_bf16 v[172:175], v[8:11], a[108:111], v[172:175]
    s_waitcnt lgkmcnt(4)
    v_exp_f32 v56, v56
    v_mfma_f32_16x16x32_bf16 v[188:191], v[12:15], a[108:111], v[188:191]
    s_xor_b32 s6, s74, 2
    ds_read_b64_tr_b16 v[8:9], v2 offset:16384
    ds_read_b64_tr_b16 v[10:11], v2 offset:17408
    v_mfma_f32_16x16x32_bf16 v[184:187], v[12:15], a[104:107], v[184:187]
    s_mul_i32 s6, s6, 40960
    v_mul_f32 v57, v49, v133
    v_mul_f32 v58, v49, v134
    v_mfma_f32_16x16x32_bf16 v[180:183], v[12:15], a[100:103], v[180:183]
    s_add_u32 s6, s6, s73
    v_exp_f32 v57, v57
    v_mfma_f32_16x16x32_bf16 v[176:179], v[12:15], a[96:99], v[176:179]
    s_waitcnt lgkmcnt(4)
    buffer_load_dwordx4 v62, s[16:19], s39 offen offset:0 sc1 lds
    v_mfma_f32_16x16x32_bf16 v[160:163], v[16:19], a[112:115], v[160:163]
    s_xor_b32 s7, s74, 3
    ds_read_b64_tr_b16 v[12:13], v2 offset:24576
    ds_read_b64_tr_b16 v[14:15], v2 offset:25600
    v_mfma_f32_16x16x32_bf16 v[164:167], v[16:19], a[116:119], v[164:167]
    s_mul_i32 s7, s7, 40960
    v_exp_f32 v58, v58
    v_mfma_f32_16x16x32_bf16 v[168:171], v[16:19], a[120:123], v[168:171]
    s_add_u32 s7, s7, s73
    v_mul_f32 v59, v49, v135
    v_mul_f32 v132, v132, v148
    v_mfma_f32_16x16x32_bf16 v[172:175], v[16:19], a[124:127], v[172:175]
    s_waitcnt lgkmcnt(4)
    v_exp_f32 v59, v59
    v_mfma_f32_16x16x32_bf16 v[188:191], v[20:23], a[124:127], v[188:191]
    ds_read_b64_tr_b16 v[16:17], v2 offset:20480
    ds_read_b64_tr_b16 v[18:19], v2 offset:21504
    v_mfma_f32_16x16x32_bf16 v[184:187], v[20:23], a[120:123], v[184:187]
    buffer_load_dwordx4 v62, s[16:19], s39 offen offset:1024 sc1 lds
    v_mfma_f32_16x16x32_bf16 v[180:183], v[20:23], a[116:119], v[180:183]
    s_add_u32 s39, s39, 30720
    v_mul_f32 v133, v133, v149
    v_mul_f32 v134, v134, v150
    v_mfma_f32_16x16x32_bf16 v[176:179], v[20:23], a[112:115], v[176:179]
    s_waitcnt lgkmcnt(4)
    v_mul_f32 v135, v135, v151
    v_fma_f32 v148, v56, v53, v53
    v_mfma_f32_16x16x32_bf16 v[160:163], v[8:11], a[128:131], v[160:163]
    ds_read_b64_tr_b16 v[20:21], v2 offset:28672
    ds_read_b64_tr_b16 v[22:23], v2 offset:29696
    v_mfma_f32_16x16x32_bf16 v[164:167], v[8:11], a[132:135], v[164:167]
    v_rcp_f32 v148, v148
    v_mfma_f32_16x16x32_bf16 v[168:171], v[8:11], a[136:139], v[168:171]
    v_fma_f32 v149, v57, v53, v53
    v_fma_f32 v150, v58, v53, v53
    v_mfma_f32_16x16x32_bf16 v[172:175], v[8:11], a[140:143], v[172:175]
    s_waitcnt lgkmcnt(4)
    v_add_u32 v2, 4294885376, v2
    v_fma_f32 v151, v59, v53, v53
    v_mfma_f32_16x16x32_bf16 v[188:191], v[12:15], a[140:143], v[188:191]
    ds_read_b64_tr_b16 v[8:9], v2 offset:0
    ds_read_b64_tr_b16 v[10:11], v2 offset:1024
    v_mfma_f32_16x16x32_bf16 v[184:187], v[12:15], a[136:139], v[184:187]
    buffer_load_dwordx4 v62, s[16:19], s39 offen offset:2048 sc1 lds
    v_mfma_f32_16x16x32_bf16 v[180:183], v[12:15], a[132:135], v[180:183]
    v_lshl_add_u32 v3, s46, 10, v62
    v_xor_b32 v4, 2048, v3
    v_mfma_f32_16x16x32_bf16 v[176:179], v[12:15], a[128:131], v[176:179]
    s_waitcnt lgkmcnt(4)
    v_rcp_f32 v149, v149
    v_mfma_f32_16x16x32_bf16 v[160:163], v[16:19], a[144:147], v[160:163]
    ds_read_b64_tr_b16 v[12:13], v2 offset:8192
    ds_read_b64_tr_b16 v[14:15], v2 offset:9216
    v_mfma_f32_16x16x32_bf16 v[164:167], v[16:19], a[148:151], v[164:167]
    v_rcp_f32 v150, v150
    v_mfma_f32_16x16x32_bf16 v[168:171], v[16:19], a[152:155], v[168:171]
    v_rcp_f32 v151, v151
    v_mfma_f32_16x16x32_bf16 v[172:175], v[16:19], a[156:159], v[172:175]
    s_waitcnt lgkmcnt(4)
    buffer_load_dwordx4 v62, s[16:19], s39 offen offset:3072 sc1 lds
    v_mfma_f32_16x16x32_bf16 v[188:191], v[20:23], a[156:159], v[188:191]
    s_sub_u32 s45, s42, 20480
    ds_read_b64_tr_b16 v[16:17], v2 offset:4096
    ds_read_b64_tr_b16 v[18:19], v2 offset:5120
    v_mfma_f32_16x16x32_bf16 v[184:187], v[20:23], a[152:155], v[184:187]
    s_xor_b32 s51, s56, 0
    v_mul_f32 v132, v132, v148
    v_mul_f32 v133, v133, v149
    v_mfma_f32_16x16x32_bf16 v[180:183], v[20:23], a[148:151], v[180:183]
    s_min_u32 s34, s42, s45
    v_mul_f32 v134, v134, v150
    v_mul_f32 v135, v135, v151
    v_mfma_f32_16x16x32_bf16 v[176:179], v[20:23], a[144:147], v[176:179]
    s_waitcnt lgkmcnt(4)
    v_cvt_pk_bf16_f32 v130, v132, v133
    v_cvt_pk_bf16_f32 v131, v134, v135
    v_mfma_f32_16x16x32_bf16 v[160:163], v[8:11], a[160:163], v[160:163]
    s_add_u32 s42, s34, 4096
    ds_read_b64_tr_b16 v[20:21], v2 offset:12288
    ds_read_b64_tr_b16 v[22:23], v2 offset:13312
    v_mfma_f32_16x16x32_bf16 v[164:167], v[8:11], a[164:167], v[164:167]
    s_sub_u32 s45, s42, 20480
    v_permlane32_swap_b32 v128, v130
    v_mfma_f32_16x16x32_bf16 v[168:171], v[8:11], a[168:171], v[168:171]
    s_min_u32 s35, s42, s45
    v_permlane32_swap_b32 v129, v131
    v_mfma_f32_16x16x32_bf16 v[172:175], v[8:11], a[172:175], v[172:175]
    s_waitcnt lgkmcnt(4)
    v_add_u32 v3, 65536, v3
    v_fmac_f32 v136, v46, v28
    v_mfma_f32_16x16x32_bf16 v[188:191], v[12:15], a[172:175], v[188:191]
    s_barrier
    ds_read_b128 v[8:11], v3 offset:0
    v_fmac_f32 v137, v46, v29
    v_mfma_f32_16x16x32_bf16 v[184:187], v[12:15], a[168:171], v[184:187]
    s_add_u32 s42, s35, 4096
    ds_read_b128 v[36:39], v63 offset:512
    ds_read_b128 v[40:43], v63 offset:768
    v_mfma_f32_16x16x32_bf16 v[180:183], v[12:15], a[164:167], v[180:183]
    buffer_store_dwordx4 v[128:131], v6, s[16:19], s51 offen sc1
    v_fmac_f32 v138, v46, v30
    v_fmac_f32 v139, v46, v31
    v_fmac_f32 v152, v46, v32
    v_mfma_f32_16x16x32_bf16 v[176:179], v[12:15], a[160:163], v[176:179]
    s_waitcnt lgkmcnt(5)
    v_add_u32 v4, 65536, v4
    v_fmac_f32 v153, v46, v33
    v_mfma_f32_16x16x32_bf16 v[160:163], v[16:19], a[176:179], v[160:163]
    s_sub_u32 s45, s42, 20480
    ds_read_b128 v[12:15], v4 offset:0
    v_fmac_f32 v154, v46, v34
    v_mfma_f32_16x16x32_bf16 v[164:167], v[16:19], a[180:183], v[164:167]
    s_min_u32 s36, s42, s45
    v_fmac_f32 v155, v46, v35
    v_mul_f32 v56, v50, v136
    v_mfma_f32_16x16x32_bf16 v[168:171], v[16:19], a[184:187], v[168:171]
    s_add_u32 s42, s36, 4096
    v_exp_f32 v56, v56
    v_mfma_f32_16x16x32_bf16 v[172:175], v[16:19], a[188:191], v[172:175]
    s_waitcnt lgkmcnt(4)
    v_mul_f32 v57, v50, v137
    v_mul_f32 v58, v50, v138
    v_mfma_f32_16x16x32_bf16 v[188:191], v[20:23], a[188:191], v[188:191]
    s_sub_u32 s45, s42, 20480
    ds_read_b128 v[16:19], v3 offset:4096
    v_mul_f32 v59, v50, v139
    v_mfma_f32_16x16x32_bf16 v[184:187], v[20:23], a[184:187], v[184:187]
    s_min_u32 s37, s42, s45
    v_exp_f32 v57, v57
    v_mfma_f32_16x16x32_bf16 v[180:183], v[20:23], a[180:183], v[180:183]
    s_add_u32 s42, s37, 4096
    v_exp_f32 v58, v58
    v_mfma_f32_16x16x32_bf16 v[176:179], v[20:23], a[176:179], v[176:179]
    s_waitcnt lgkmcnt(4)
    v_exp_f32 v59, v59
    v_mfma_f32_16x16x32_bf16 v[64:67], v[8:11], v[192:195], 0
    s_sub_u32 s45, s42, 20480
    ds_read_b128 v[20:23], v4 offset:4096
    v_mul_f32 v136, v136, v152
    v_mfma_f32_16x16x32_bf16 v[68:71], v[8:11], v[196:199], 0
    s_xor_b32 s80, s75, 2
    s_mul_i32 s80, s80, 40960
    v_mul_f32 v137, v137, v153
    v_mfma_f32_16x16x32_bf16 v[72:75], v[8:11], v[200:203], 0
    s_add_u32 s80, s80, s73
    v_mul_f32 v138, v138, v154
    v_mul_f32 v139, v139, v155
    v_mfma_f32_16x16x32_bf16 v[76:79], v[8:11], v[204:207], 0
    s_min_u32 s38, s42, s45
    v_fma_f32 v152, v56, v54, v54
    v_fma_f32 v153, v57, v54, v54
    v_mfma_f32_16x16x32_bf16 v[120:123], v[8:11], v[24:27], 0
    s_waitcnt lgkmcnt(2)
    v_rcp_f32 v152, v152
    v_mfma_f32_16x16x32_bf16 v[92:95], v[12:15], v[204:207], 0
    s_andn2_b32 s79, s79, 0xc00
    ds_read_b128 v[8:11], v3 offset:8192
    v_fma_f32 v154, v58, v54, v54
    v_mfma_f32_16x16x32_bf16 v[88:91], v[12:15], v[200:203], 0
    s_mul_i32 s59, s34, 10
    v_rcp_f32 v153, v153
    v_mfma_f32_16x16x32_bf16 v[84:87], v[12:15], v[196:199], 0
    buffer_load_dwordx4 v[204:207], v62, s[16:19], s80 offen offset:0 sc1
    v_mfma_f32_16x16x32_bf16 v[80:83], v[12:15], v[192:195], 0
    s_waitcnt lgkmcnt(2)
    v_rcp_f32 v154, v154
    v_mfma_f32_16x16x32_bf16 v[64:67], v[16:19], v[208:211], v[64:67]
    s_add_u32 s59, s59, s76
    ds_read_b128 v[12:15], v4 offset:8192
    v_fma_f32 v155, v59, v54, v54
    v_mfma_f32_16x16x32_bf16 v[68:71], v[16:19], v[212:215], v[68:71]
    s_add_u32 s34, s34, s79
    v_rcp_f32 v155, v155
    v_mfma_f32_16x16x32_bf16 v[72:75], v[16:19], v[216:219], v[72:75]
    buffer_load_dwordx4 v[192:195], v62, s[16:19], s80 offen offset:1024 sc1
    v_mfma_f32_16x16x32_bf16 v[76:79], v[16:19], v[220:223], v[76:79]
    s_mul_i32 s60, s35, 10
    v_mul_f32 v136, v136, v152
    v_mul_f32 v137, v137, v153
    v_mfma_f32_16x16x32_bf16 v[120:123], v[16:19], v[24:27], v[120:123]
    s_waitcnt lgkmcnt(2)
    v_mul_f32 v138, v138, v154
    v_mul_f32 v139, v139, v155
    v_mfma_f32_16x16x32_bf16 v[92:95], v[20:23], v[220:223], v[92:95]
    s_add_u32 s60, s60, s76
    ds_read_b128 v[16:19], v3 offset:12288
    v_cvt_pk_bf16_f32 v136, v136, v137
    v_mfma_f32_16x16x32_bf16 v[88:91], v[20:23], v[216:219], v[88:91]
    buffer_load_dwordx4 v[196:199], v62, s[16:19], s80 offen offset:2048 sc1
    v_mfma_f32_16x16x32_bf16 v[84:87], v[20:23], v[212:215], v[84:87]
    s_add_u32 s35, s35, s79
    v_cvt_pk_bf16_f32 v137, v138, v139
    v_fmac_f32 v140, v47, v28
    v_mfma_f32_16x16x32_bf16 v[80:83], v[20:23], v[208:211], v[80:83]
    s_waitcnt lgkmcnt(2)
    v_fmac_f32 v141, v47, v29
    v_fmac_f32 v142, v47, v30
    v_mfma_f32_16x16x32_bf16 v[64:67], v[8:11], v[224:227], v[64:67]
    s_mul_i32 s61, s36, 10
    ds_read_b128 v[20:23], v4 offset:12288
    v_fmac_f32 v143, v47, v31
    v_mfma_f32_16x16x32_bf16 v[68:71], v[8:11], v[228:231], v[68:71]
    buffer_load_dwordx4 v[200:203], v62, s[16:19], s80 offen offset:3072 sc1
    v_mfma_f32_16x16x32_bf16 v[72:75], v[8:11], v[232:235], v[72:75]
    s_add_u32 s80, s80, 4096
    v_fmac_f32 v156, v47, v32
    v_fmac_f32 v157, v47, v33
    v_mfma_f32_16x16x32_bf16 v[76:79], v[8:11], v[236:239], v[76:79]
    s_add_u32 s61, s61, s76
    v_fmac_f32 v158, v47, v34
    v_fmac_f32 v159, v47, v35
    v_mfma_f32_16x16x32_bf16 v[120:123], v[8:11], v[24:27], v[120:123]
    s_waitcnt lgkmcnt(2)
    v_add_u32 v3, 4294950912, v3
    v_mul_f32 v56, v51, v140
    v_mfma_f32_16x16x32_bf16 v[92:95], v[12:15], v[236:239], v[92:95]
    s_barrier
    ds_read_b128 v[8:11], v3 offset:0
    v_mul_f32 v57, v51, v141
    v_mfma_f32_16x16x32_bf16 v[88:91], v[12:15], v[232:235], v[88:91]
    buffer_load_dwordx4 v[208:211], v62, s[16:19], s80 offen offset:0 sc1
    v_mfma_f32_16x16x32_bf16 v[84:87], v[12:15], v[228:231], v[84:87]
    s_add_u32 s36, s36, s79
    v_exp_f32 v56, v56
    v_mfma_f32_16x16x32_bf16 v[80:83], v[12:15], v[224:227], v[80:83]
    s_waitcnt lgkmcnt(2)
    v_add_u32 v4, 4294950912, v4
    v_mul_f32 v58, v51, v142
    v_mfma_f32_16x16x32_bf16 v[64:67], v[16:19], v[240:243], v[64:67]
    s_mul_i32 s62, s37, 10
    ds_read_b128 v[12:15], v4 offset:0
    v_mul_f32 v59, v51, v143
    v_mfma_f32_16x16x32_bf16 v[68:71], v[16:19], v[244:247], v[68:71]
    buffer_load_dwordx4 v[212:215], v62, s[16:19], s49 offen offset:0 sc1
    v_mfma_f32_16x16x32_bf16 v[72:75], v[16:19], v[248:251], v[72:75]
    s_add_u32 s62, s62, s76
    v_exp_f32 v57, v57
    v_mfma_f32_16x16x32_bf16 v[76:79], v[16:19], v[252:255], v[76:79]
    buffer_load_dword v124, v61, s[16:19], s70 offen sc1
    v_mfma_f32_16x16x32_bf16 v[120:123], v[16:19], v[24:27], v[120:123]
    s_waitcnt lgkmcnt(2)
    v_exp_f32 v58, v58
    v_mfma_f32_16x16x32_bf16 v[92:95], v[20:23], v[252:255], v[92:95]
    s_add_u32 s37, s37, s79
    ds_read_b128 v[16:19], v3 offset:4096
    v_mul_f32 v140, v140, v156
    v_mfma_f32_16x16x32_bf16 v[88:91], v[20:23], v[248:251], v[88:91]
    buffer_load_dwordx4 v[216:219], v62, s[16:19], s49 offen offset:1024 sc1
    v_mfma_f32_16x16x32_bf16 v[84:87], v[20:23], v[244:247], v[84:87]
    s_mul_i32 s63, s38, 10
    v_exp_f32 v59, v59
    v_mfma_f32_16x16x32_bf16 v[80:83], v[20:23], v[240:243], v[80:83]
    s_waitcnt lgkmcnt(2)
    v_mul_f32 v141, v141, v157
    v_mul_f32 v142, v142, v158
    v_mfma_f32_16x16x32_bf16 v[64:67], v[8:11], a[192:195], v[64:67]
    s_add_u32 s63, s63, s76
    ds_read_b128 v[20:23], v4 offset:4096
    v_mul_f32 v143, v143, v159
    v_mfma_f32_16x16x32_bf16 v[68:71], v[8:11], a[196:199], v[68:71]
    buffer_load_dwordx4 v[220:223], v62, s[16:19], s49 offen offset:2048 sc1
    v_mfma_f32_16x16x32_bf16 v[72:75], v[8:11], a[200:203], v[72:75]
    s_add_u32 s38, s38, s79
    v_fma_f32 v156, v56, v55, v55
    v_fma_f32 v157, v57, v55, v55
    v_mfma_f32_16x16x32_bf16 v[76:79], v[8:11], a[204:207], v[76:79]
    v_rcp_f32 v156, v156
    v_mfma_f32_16x16x32_bf16 v[120:123], v[8:11], v[24:27], v[120:123]
    s_waitcnt lgkmcnt(2)
    v_rcp_f32 v157, v157
    v_mfma_f32_16x16x32_bf16 v[92:95], v[12:15], a[204:207], v[92:95]
    ds_read_b128 v[8:11], v3 offset:8192
    v_fma_f32 v158, v58, v55, v55
    v_mfma_f32_16x16x32_bf16 v[88:91], v[12:15], a[200:203], v[88:91]
    buffer_load_dwordx4 v[224:227], v62, s[16:19], s49 offen offset:3072 sc1
    v_mfma_f32_16x16x32_bf16 v[84:87], v[12:15], a[196:199], v[84:87]
    v_rcp_f32 v158, v158
    v_mfma_f32_16x16x32_bf16 v[80:83], v[12:15], a[192:195], v[80:83]
    s_waitcnt lgkmcnt(2)
    v_fma_f32 v159, v59, v55, v55
    v_mul_f32 v140, v140, v156
    v_mfma_f32_16x16x32_bf16 v[64:67], v[16:19], a[208:211], v[64:67]
    s_xor_b32 s51, s56, 2048
    ds_read_b128 v[12:15], v4 offset:8192
    v_mul_f32 v141, v141, v157
    v_mfma_f32_16x16x32_bf16 v[68:71], v[16:19], a[212:215], v[68:71]
    buffer_load_dwordx4 v[228:231], v119, s[16:19], s49 offen offset:0 sc1
    v_mfma_f32_16x16x32_bf16 v[72:75], v[16:19], a[216:219], v[72:75]
    v_rcp_f32 v159, v159
    v_mfma_f32_16x16x32_bf16 v[76:79], v[16:19], a[220:223], v[76:79]
    v_mul_f32 v142, v142, v158
    v_mul_f32 v143, v143, v159
    v_mfma_f32_16x16x32_bf16 v[120:123], v[16:19], v[24:27], v[120:123]
    s_waitcnt lgkmcnt(2)
    v_cvt_pk_bf16_f32 v138, v140, v141
    v_cvt_pk_bf16_f32 v139, v142, v143
    v_mfma_f32_16x16x32_bf16 v[92:95], v[20:23], a[220:223], v[92:95]
    ds_read_b128 v[16:19], v3 offset:12288
    v_mfma_f32_16x16x32_bf16 v[88:91], v[20:23], a[216:219], v[88:91]
    buffer_load_dwordx4 v[232:235], v62, s[16:19], s50 offen offset:0 sc1
    v_mfma_f32_16x16x32_bf16 v[84:87], v[20:23], a[212:215], v[84:87]
    v_permlane32_swap_b32 v136, v138
    v_mfma_f32_16x16x32_bf16 v[80:83], v[20:23], a[208:211], v[80:83]
    s_waitcnt lgkmcnt(2)
    v_permlane32_swap_b32 v137, v139
    v_mfma_f32_16x16x32_bf16 v[64:67], v[8:11], a[224:227], v[64:67]
    ds_read_b128 v[20:23], v4 offset:12288
    v_mfma_f32_16x16x32_bf16 v[68:71], v[8:11], a[228:231], v[68:71]
    buffer_load_dwordx4 v[236:239], v62, s[16:19], s50 offen offset:1024 sc1
    v_mfma_f32_16x16x32_bf16 v[72:75], v[8:11], a[232:235], v[72:75]
    buffer_store_dwordx4 v[136:139], v6, s[16:19], s51 offen sc1
    v_mfma_f32_16x16x32_bf16 v[76:79], v[8:11], a[236:239], v[76:79]
    v_fmac_f32 v160, v44, v36
    v_fmac_f32 v161, v44, v37
    v_mfma_f32_16x16x32_bf16 v[120:123], v[8:11], v[24:27], v[120:123]
    s_waitcnt vmcnt(32) lgkmcnt(2)
    v_fmac_f32 v162, v44, v38
    v_fmac_f32 v163, v44, v39
    v_mfma_f32_16x16x32_bf16 v[92:95], v[12:15], a[236:239], v[92:95]
    s_barrier
    ds_read_b128 v[8:11], v3 offset:32768
    v_fmac_f32 v176, v44, v40
    v_mfma_f32_16x16x32_bf16 v[88:91], v[12:15], a[232:235], v[88:91]
    buffer_load_dwordx4 v[128:131], v62, s[16:19], s50 offen offset:2048 sc1
    v_mfma_f32_16x16x32_bf16 v[84:87], v[12:15], a[228:231], v[84:87]
    v_fmac_f32 v177, v44, v41
    v_fmac_f32 v178, v44, v42
    v_mfma_f32_16x16x32_bf16 v[80:83], v[12:15], a[224:227], v[80:83]
    s_waitcnt lgkmcnt(2)
    v_fmac_f32 v179, v44, v43
    v_mul_f32 v56, v48, v160
    v_mfma_f32_16x16x32_bf16 v[64:67], v[16:19], a[240:243], v[64:67]
    ds_read_b128 v[12:15], v4 offset:32768
    v_mul_f32 v57, v48, v161
    v_mfma_f32_16x16x32_bf16 v[68:71], v[16:19], a[244:247], v[68:71]
    buffer_load_dwordx4 v[132:135], v62, s[16:19], s50 offen offset:3072 sc1
    v_mfma_f32_16x16x32_bf16 v[72:75], v[16:19], a[248:251], v[72:75]
    v_exp_f32 v56, v56
    v_mfma_f32_16x16x32_bf16 v[76:79], v[16:19], a[252:255], v[76:79]
    v_exp_f32 v57, v57
    v_mfma_f32_16x16x32_bf16 v[120:123], v[16:19], v[24:27], v[120:123]
    s_waitcnt lgkmcnt(2)
    v_mul_f32 v58, v48, v162
    v_mul_f32 v59, v48, v163
    v_mfma_f32_16x16x32_bf16 v[92:95], v[20:23], a[252:255], v[92:95]
    ds_read_b128 v[16:19], v3 offset:36864
    v_mul_f32 v160, v160, v176
    v_mfma_f32_16x16x32_bf16 v[88:91], v[20:23], a[248:251], v[88:91]
    buffer_load_dwordx4 v[136:139], v119, s[16:19], s50 offen offset:0 sc1
    v_mfma_f32_16x16x32_bf16 v[84:87], v[20:23], a[244:247], v[84:87]
    v_exp_f32 v58, v58
    v_mfma_f32_16x16x32_bf16 v[80:83], v[20:23], a[240:243], v[80:83]
    s_waitcnt lgkmcnt(2)
    s_add_u32 s3, s64, 81920
    v_mul_f32 v161, v161, v177
    v_mfma_f32_16x16x32_bf16 v[64:67], v[8:11], a[0:3], v[64:67]
    ds_read_b128 v[20:23], v4 offset:36864
    v_mul_f32 v162, v162, v178
    v_mfma_f32_16x16x32_bf16 v[68:71], v[8:11], a[4:7], v[68:71]
    buffer_load_dwordx4 v[140:143], v62, s[16:19], s43 offen offset:0 sc1
    v_mfma_f32_16x16x32_bf16 v[72:75], v[8:11], a[8:11], v[72:75]
    v_exp_f32 v59, v59
    v_mfma_f32_16x16x32_bf16 v[76:79], v[8:11], a[12:15], v[76:79]
    s_waitcnt vmcnt(11)
    v_cmp_ne_u32 vcc, 0x101, v124
    v_mul_f32 v163, v163, v179
    v_mfma_f32_16x16x32_bf16 v[120:123], v[8:11], v[24:27], v[120:123]
    s_cbranch_vccnz K_slow1
K_back1:
    v_fma_f32 v176, v56, v52, v52
    s_waitcnt lgkmcnt(2)
    v_mfma_f32_16x16x32_bf16 v[92:95], v[12:15], a[12:15], v[92:95]
    ds_read_b128 v[8:11], v3 offset:40960
    v_fma_f32 v177, v57, v52, v52
    v_mfma_f32_16x16x32_bf16 v[88:91], v[12:15], a[8:11], v[88:91]
    buffer_load_dwordx4 a[196:199], v62, s[16:19], s3 offen offset:0 sc1
    v_mfma_f32_16x16x32_bf16 v[84:87], v[12:15], a[4:7], v[84:87]
    v_rcp_f32 v176, v176
    v_mfma_f32_16x16x32_bf16 v[80:83], v[12:15], a[0:3], v[80:83]
    s_waitcnt lgkmcnt(2)
    v_rcp_f32 v177, v177
    v_mfma_f32_16x16x32_bf16 v[64:67], v[16:19], a[16:19], v[64:67]
    ds_read_b128 v[12:15], v4 offset:40960
    v_fma_f32 v178, v58, v52, v52
    v_mfma_f32_16x16x32_bf16 v[68:71], v[16:19], a[20:23], v[68:71]
    buffer_load_dwordx4 a[0:3], v62, s[16:19], s43 offen offset:1024 sc1
    v_mfma_f32_16x16x32_bf16 v[72:75], v[16:19], a[24:27], v[72:75]
    v_rcp_f32 v178, v178
    v_mfma_f32_16x16x32_bf16 v[76:79], v[16:19], a[28:31], v[76:79]
    v_fma_f32 v179, v59, v52, v52
    v_mul_f32 v160, v160, v176
    v_mfma_f32_16x16x32_bf16 v[120:123], v[16:19], v[24:27], v[120:123]
    s_waitcnt lgkmcnt(2)
    v_rcp_f32 v179, v179
    v_mfma_f32_16x16x32_bf16 v[92:95], v[20:23], a[28:31], v[92:95]
    ds_read_b128 v[16:19], v3 offset:45056
    v_mul_f32 v161, v161, v177
    v_mfma_f32_16x16x32_bf16 v[88:91], v[20:23], a[24:27], v[88:91]
    buffer_load_dwordx4 a[200:203], v62, s[16:19], s3 offen offset:1024 sc1
    v_mfma_f32_16x16x32_bf16 v[84:87], v[20:23], a[20:23], v[84:87]
    v_mul_f32 v162, v162, v178
    v_mul_f32 v163, v163, v179
    v_mfma_f32_16x16x32_bf16 v[80:83], v[20:23], a[16:19], v[80:83]
    s_waitcnt lgkmcnt(2)
    v_cvt_pk_bf16_f32 v160, v160, v161
    v_cvt_pk_bf16_f32 v161, v162, v163
    v_mfma_f32_16x16x32_bf16 v[64:67], v[8:11], a[32:35], v[64:67]
    ds_read_b128 v[20:23], v4 offset:45056
    v_fmac_f32 v164, v45, v36
    v_mfma_f32_16x16x32_bf16 v[68:71], v[8:11], a[36:39], v[68:71]
    buffer_load_dwordx4 a[4:7], v62, s[16:19], s43 offen offset:2048 sc1
    v_mfma_f32_16x16x32_bf16 v[72:75], v[8:11], a[40:43], v[72:75]
    v_fmac_f32 v165, v45, v37
    v_fmac_f32 v166, v45, v38
    v_mfma_f32_16x16x32_bf16 v[76:79], v[8:11], a[44:47], v[76:79]
    v_fmac_f32 v167, v45, v39
    v_fmac_f32 v180, v45, v40
    v_mfma_f32_16x16x32_bf16 v[120:123], v[8:11], v[24:27], v[120:123]
    s_waitcnt lgkmcnt(2)
    v_add_u32 v3, 4294918144, v3
    v_fmac_f32 v181, v45, v41
    v_mfma_f32_16x16x32_bf16 v[92:95], v[12:15], a[44:47], v[92:95]
    s_barrier
    ds_read_b128 v[8:11], v3 offset:0
    v_fmac_f32 v182, v45, v42
    v_mfma_f32_16x16x32_bf16 v[88:91], v[12:15], a[40:43], v[88:91]
    buffer_load_dwordx4 a[204:207], v117, s[16:19], s64 offen offset:1024 sc1
    v_mfma_f32_16x16x32_bf16 v[84:87], v[12:15], a[36:39], v[84:87]
    v_fmac_f32 v183, v45, v43
    v_mul_f32 v56, v49, v164
    v_mfma_f32_16x16x32_bf16 v[80:83], v[12:15], a[32:35], v[80:83]
    s_waitcnt lgkmcnt(2)
    s_add_u32 s3, s65, 81920
    v_add_u32 v4, 4294918144, v4
    v_mfma_f32_16x16x32_bf16 v[64:67], v[16:19], a[48:51], v[64:67]
    ds_read_b128 v[12:15], v4 offset:0
    v_mul_f32 v57, v49, v165
    v_mfma_f32_16x16x32_bf16 v[68:71], v[16:19], a[52:55], v[68:71]
    buffer_load_dwordx4 a[8:11], v62, s[16:19], s43 offen offset:3072 sc1
    v_mfma_f32_16x16x32_bf16 v[72:75], v[16:19], a[56:59], v[72:75]
    s_waitcnt vmcnt(10)
    s_add_u32 s69, s69, 65536
    v_mul_f32 v58, v49, v166
    v_mfma_f32_16x16x32_bf16 v[76:79], v[16:19], a[60:63], v[76:79]
    buffer_store_byte v116, v5, s[16:19], s69 offen sc1
    v_mfma_f32_16x16x32_bf16 v[120:123], v[16:19], v[24:27], v[120:123]
    s_waitcnt lgkmcnt(2)
    v_exp_f32 v56, v56
    v_mfma_f32_16x16x32_bf16 v[92:95], v[20:23], a[60:63], v[92:95]
    ds_read_b128 v[16:19], v3 offset:4096
    v_mul_f32 v59, v49, v167
    v_mfma_f32_16x16x32_bf16 v[88:91], v[20:23], a[56:59], v[88:91]
    buffer_load_dwordx2 a[208:209], v62, s[16:19], s3 offen offset:8 sc1
    v_mfma_f32_16x16x32_bf16 v[84:87], v[20:23], a[52:55], v[84:87]
    v_exp_f32 v57, v57
    v_mfma_f32_16x16x32_bf16 v[80:83], v[20:23], a[48:51], v[80:83]
    s_waitcnt lgkmcnt(2)
    v_exp_f32 v58, v58
    v_mfma_f32_16x16x32_bf16 v[64:67], v[8:11], a[64:67], v[64:67]
    ds_read_b128 v[20:23], v4 offset:4096
    v_mul_f32 v164, v164, v180
    v_mfma_f32_16x16x32_bf16 v[68:71], v[8:11], a[68:71], v[68:71]
    buffer_load_dwordx4 a[12:15], v119, s[16:19], s43 offen offset:0 sc1
    v_mfma_f32_16x16x32_bf16 v[72:75], v[8:11], a[72:75], v[72:75]
    v_exp_f32 v59, v59
    v_mfma_f32_16x16x32_bf16 v[76:79], v[8:11], a[76:79], v[76:79]
    v_mul_f32 v165, v165, v181
    v_mul_f32 v166, v166, v182
    v_mfma_f32_16x16x32_bf16 v[120:123], v[8:11], v[24:27], v[120:123]
    s_waitcnt lgkmcnt(2)
    v_mul_f32 v167, v167, v183
    v_fma_f32 v180, v56, v53, v53
    v_mfma_f32_16x16x32_bf16 v[92:95], v[12:15], a[76:79], v[92:95]
    ds_read_b128 v[8:11], v3 offset:8192
    v_fma_f32 v181, v57, v53, v53
    v_mfma_f32_16x16x32_bf16 v[88:91], v[12:15], a[72:75], v[88:91]
    buffer_load_dwordx2 a[210:211], v62, s[16:19], s3 offen offset:1032 sc1
    v_mfma_f32_16x16x32_bf16 v[84:87], v[12:15], a[68:71], v[84:87]
    v_rcp_f32 v180, v180
    v_mfma_f32_16x16x32_bf16 v[80:83], v[12:15], a[64:67], v[80:83]
    s_waitcnt lgkmcnt(2)
    v_rcp_f32 v181, v181
    v_mfma_f32_16x16x32_bf16 v[64:67], v[16:19], a[80:83], v[64:67]
    ds_read_b128 v[12:15], v4 offset:8192
    v_fma_f32 v182, v58, v53, v53
    v_mfma_f32_16x16x32_bf16 v[68:71], v[16:19], a[84:87], v[68:71]
    buffer_load_dwordx4 a[16:19], v62, s[16:19], s81 offen offset:0 sc1
    v_mfma_f32_16x16x32_bf16 v[72:75], v[16:19], a[88:91], v[72:75]
    v_rcp_f32 v182, v182
    v_mfma_f32_16x16x32_bf16 v[76:79], v[16:19], a[92:95], v[76:79]
    v_fma_f32 v183, v59, v53, v53
    v_mul_f32 v164, v164, v180
    v_mfma_f32_16x16x32_bf16 v[120:123], v[16:19], v[24:27], v[120:123]
    s_waitcnt lgkmcnt(2)
    v_rcp_f32 v183, v183
    v_mfma_f32_16x16x32_bf16 v[92:95], v[20:23], a[92:95], v[92:95]
    s_xor_b32 s51, s56, 4096
    ds_read_b128 v[16:19], v3 offset:12288
    v_mul_f32 v165, v165, v181
    v_mfma_f32_16x16x32_bf16 v[88:91], v[20:23], a[88:91], v[88:91]
    buffer_load_dwordx2 a[212:213], v117, s[16:19], s65 offen offset:1032 sc1
    v_mfma_f32_16x16x32_bf16 v[84:87], v[20:23], a[84:87], v[84:87]
    v_mul_f32 v166, v166, v182
    v_mul_f32 v167, v167, v183
    v_mfma_f32_16x16x32_bf16 v[80:83], v[20:23], a[80:83], v[80:83]
    s_waitcnt lgkmcnt(2)
    v_cvt_pk_bf16_f32 v162, v164, v165
    v_cvt_pk_bf16_f32 v163, v166, v167
    v_mfma_f32_16x16x32_bf16 v[64:67], v[8:11], a[96:99], v[64:67]
    ds_read_b128 v[20:23], v4 offset:12288
    v_fmac_f32 v168, v46, v36
    v_mfma_f32_16x16x32_bf16 v[68:71], v[8:11], a[100:103], v[68:71]
    buffer_load_dwordx4 a[20:23], v62, s[16:19], s81 offen offset:1024 sc1
    v_mfma_f32_16x16x32_bf16 v[72:75], v[8:11], a[104:107], v[72:75]
    v_permlane32_swap_b32 v160, v162
    v_mfma_f32_16x16x32_bf16 v[76:79], v[8:11], a[108:111], v[76:79]
    v_permlane32_swap_b32 v161, v163
    v_mfma_f32_16x16x32_bf16 v[120:123], v[8:11], v[24:27], v[120:123]
    s_waitcnt lgkmcnt(2)
    v_add_u32 v3, 98304, v3
    v_fmac_f32 v169, v46, v37
    v_mfma_f32_16x16x32_bf16 v[92:95], v[12:15], a[108:111], v[92:95]
    s_barrier
    ds_read_b128 v[8:11], v3 offset:0
    v_fmac_f32 v170, v46, v38
    v_mfma_f32_16x16x32_bf16 v[88:91], v[12:15], a[104:107], v[88:91]
    buffer_load_dwordx4 a[216:219], v62, s[16:19], s64 offen offset:0 sc1
    v_mfma_f32_16x16x32_bf16 v[84:87], v[12:15], a[100:103], v[84:87]
    buffer_store_dwordx4 v[160:163], v6, s[16:19], s51 offen sc1
    v_fmac_f32 v171, v46, v39
    v_fmac_f32 v184, v46, v40
    v_fmac_f32 v185, v46, v41
    v_mfma_f32_16x16x32_bf16 v[80:83], v[12:15], a[96:99], v[80:83]
    s_waitcnt lgkmcnt(2)
    v_fmac_f32 v186, v46, v42
    v_fmac_f32 v187, v46, v43
    v_mfma_f32_16x16x32_bf16 v[64:67], v[16:19], a[112:115], v[64:67]
    ds_read_b128 v[12:15], v3 offset:4096
    v_mul_f32 v56, v50, v168
    v_mfma_f32_16x16x32_bf16 v[68:71], v[16:19], a[116:119], v[68:71]
    buffer_load_dwordx4 a[24:27], v62, s[16:19], s81 offen offset:2048 sc1
    v_mfma_f32_16x16x32_bf16 v[72:75], v[16:19], a[120:123], v[72:75]
    v_exp_f32 v56, v56
    v_mfma_f32_16x16x32_bf16 v[76:79], v[16:19], a[124:127], v[76:79]
    v_mul_f32 v57, v50, v169
    v_mul_f32 v58, v50, v170
    v_mfma_f32_16x16x32_bf16 v[120:123], v[16:19], v[24:27], v[120:123]
    s_waitcnt lgkmcnt(2)
    v_exp_f32 v57, v57
    v_mfma_f32_16x16x32_bf16 v[92:95], v[20:23], a[124:127], v[92:95]
    ds_read_b128 v[16:19], v3 offset:8192
    v_mul_f32 v59, v50, v171
    v_mfma_f32_16x16x32_bf16 v[88:91], v[20:23], a[120:123], v[88:91]
    buffer_load_dwordx4 a[220:223], v62, s[16:19], s64 offen offset:1280 sc1
    v_mfma_f32_16x16x32_bf16 v[84:87], v[20:23], a[116:119], v[84:87]
    v_exp_f32 v58, v58
    v_mfma_f32_16x16x32_bf16 v[80:83], v[20:23], a[112:115], v[80:83]
    s_waitcnt lgkmcnt(2)
    v_exp_f32 v59, v59
    v_mfma_f32_16x16x32_bf16 v[64:67], v[8:11], a[128:131], v[64:67]
    ds_read_b128 v[20:23], v3 offset:12288
    v_mul_f32 v168, v168, v184
    v_mfma_f32_16x16x32_bf16 v[68:71], v[8:11], a[132:135], v[68:71]
    buffer_load_dwordx4 a[28:31], v62, s[16:19], s81 offen offset:3072 sc1
    v_mfma_f32_16x16x32_bf16 v[72:75], v[8:11], a[136:139], v[72:75]
    v_mul_f32 v169, v169, v185
    v_mul_f32 v170, v170, v186
    v_mfma_f32_16x16x32_bf16 v[76:79], v[8:11], a[140:143], v[76:79]
    v_mul_f32 v171, v171, v187
    v_fma_f32 v184, v56, v54, v54
    v_mfma_f32_16x16x32_bf16 v[120:123], v[8:11], v[24:27], v[120:123]
    s_waitcnt lgkmcnt(2)
    v_add_u32 v4, 98304, v4
    v_fma_f32 v185, v57, v54, v54
    v_mfma_f32_16x16x32_bf16 v[76:79], v[12:15], a[156:159], v[76:79]
    ds_read_b128 v[8:11], v4 offset:0
    v_fma_f32 v186, v58, v54, v54
    v_mfma_f32_16x16x32_bf16 v[72:75], v[12:15], a[152:155], v[72:75]
    buffer_load_dwordx4 a[224:227], v118, s[16:19], s64 offen offset:1024 sc1
    v_mfma_f32_16x16x32_bf16 v[68:71], v[12:15], a[148:151], v[68:71]
    v_rcp_f32 v184, v184
    v_mfma_f32_16x16x32_bf16 v[64:67], v[12:15], a[144:147], v[64:67]
    v_rcp_f32 v185, v185
    v_mfma_f32_16x16x32_bf16 v[120:123], v[12:15], v[24:27], v[120:123]
    s_waitcnt lgkmcnt(2)
    v_rcp_f32 v186, v186
    v_mfma_f32_16x16x32_bf16 v[64:67], v[16:19], a[160:163], v[64:67]
    ds_read_b128 v[12:15], v4 offset:4096
    v_fma_f32 v187, v59, v54, v54
    v_mfma_f32_16x16x32_bf16 v[68:71], v[16:19], a[164:167], v[68:71]
    buffer_load_dwordx4 a[32:35], v119, s[16:19], s81 offen offset:0 sc1
    v_mfma_f32_16x16x32_bf16 v[72:75], v[16:19], a[168:171], v[72:75]
    v_rcp_f32 v187, v187
    v_mfma_f32_16x16x32_bf16 v[76:79], v[16:19], a[172:175], v[76:79]
    v_mul_f32 v168, v168, v184
    v_mul_f32 v169, v169, v185
    v_mfma_f32_16x16x32_bf16 v[120:123], v[16:19], v[24:27], v[120:123]
    s_waitcnt lgkmcnt(2)
    v_mul_f32 v170, v170, v186
    v_mul_f32 v171, v171, v187
    v_mfma_f32_16x16x32_bf16 v[76:79], v[20:23], a[188:191], v[76:79]
    ds_read_b128 v[16:19], v4 offset:8192
    v_cvt_pk_bf16_f32 v168, v168, v169
    v_mfma_f32_16x16x32_bf16 v[72:75], v[20:23], a[184:187], v[72:75]
    buffer_load_dwordx4 a[228:231], v60, s[16:19], s64 offen offset:1024 sc1
    v_mfma_f32_16x16x32_bf16 v[68:71], v[20:23], a[180:183], v[68:71]
    v_cvt_pk_bf16_f32 v169, v170, v171
    v_fmac_f32 v172, v47, v36
    v_mfma_f32_16x16x32_bf16 v[64:67], v[20:23], a[176:179], v[64:67]
    v_fmac_f32 v173, v47, v37
    v_fmac_f32 v174, v47, v38
    v_mfma_f32_16x16x32_bf16 v[120:123], v[20:23], v[24:27], v[120:123]
    s_waitcnt lgkmcnt(2)
    s_add_u32 s3, s64, 40960
    v_fmac_f32 v175, v47, v39
    v_mfma_f32_16x16x32_bf16 v[80:83], v[8:11], a[128:131], v[80:83]
    ds_read_b128 v[20:23], v4 offset:12288
    v_fmac_f32 v188, v47, v40
    v_mfma_f32_16x16x32_bf16 v[84:87], v[8:11], a[132:135], v[84:87]
    buffer_load_dwordx4 a[36:39], v62, s[16:19], s54 offen offset:0 sc1
    v_mfma_f32_16x16x32_bf16 v[88:91], v[8:11], a[136:139], v[88:91]
    v_fmac_f32 v189, v47, v41
    v_fmac_f32 v190, v47, v42
    v_mfma_f32_16x16x32_bf16 v[92:95], v[8:11], a[140:143], v[92:95]
    s_waitcnt lgkmcnt(2)
    v_fmac_f32 v191, v47, v43
    v_mul_f32 v56, v51, v172
    v_mfma_f32_16x16x32_bf16 v[92:95], v[12:15], a[156:159], v[92:95]
    ds_write_b128 v7, v[120:123] offset:1024
    v_mfma_f32_16x16x32_bf16 v[88:91], v[12:15], a[152:155], v[88:91]
    buffer_load_dwordx4 a[40:43], v62, s[16:19], s3 offen offset:0 sc1
    v_mfma_f32_16x16x32_bf16 v[84:87], v[12:15], a[148:151], v[84:87]
    v_exp_f32 v56, v56
    v_mfma_f32_16x16x32_bf16 v[80:83], v[12:15], a[144:147], v[80:83]
    s_waitcnt lgkmcnt(2)
    v_mul_f32 v57, v51, v173
    v_mul_f32 v58, v51, v174
    v_mfma_f32_16x16x32_bf16 v[80:83], v[16:19], a[160:163], v[80:83]
    s_waitcnt lgkmcnt(0)
    v_exp_f32 v57, v57
    v_mfma_f32_16x16x32_bf16 v[84:87], v[16:19], a[164:167], v[84:87]
    s_barrier
    v_exp_f32 v58, v58
    v_mfma_f32_16x16x32_bf16 v[88:91], v[16:19], a[168:171], v[88:91]
    buffer_load_dwordx4 a[44:47], v62, s[16:19], s54 offen offset:1024 sc1
    v_mfma_f32_16x16x32_bf16 v[92:95], v[16:19], a[172:175], v[92:95]
    ds_read_b128 v[32:35], v63 offset:1024
    v_mul_f32 v59, v51, v175
    v_mfma_f32_16x16x32_bf16 v[92:95], v[20:23], a[188:191], v[92:95]
    v_exp_f32 v59, v59
    v_mfma_f32_16x16x32_bf16 v[88:91], v[20:23], a[184:187], v[88:91]
    v_mul_f32 v172, v172, v188
    v_mul_f32 v173, v173, v189
    v_mfma_f32_16x16x32_bf16 v[84:87], v[20:23], a[180:183], v[84:87]
    buffer_load_dwordx4 a[48:51], v62, s[16:19], s3 offen offset:1280 sc1
    v_mfma_f32_16x16x32_bf16 v[80:83], v[20:23], a[176:179], v[80:83]
    s_add_u32 s3, s65, 40960
    v_mul_f32 v174, v174, v190
    v_mul_f32 v175, v175, v191
    v_pk_fma_f32 v[188:189], v[56:57], v[54:55], v[54:55] op_sel:[0,1,1] op_sel_hi:[1,1,1]
    v_rcp_f32 v188, v188
    v_pk_fma_f32 v[190:191], v[58:59], v[54:55], v[54:55] op_sel:[0,1,1] op_sel_hi:[1,1,1]
    s_xor_b32 s51, s56, 6144
    v_rcp_f32 v189, v189
    v_rcp_f32 v190, v190
    buffer_load_dwordx2 a[52:53], v62, s[16:19], s3 offen offset:8 sc1
    v_pk_mul_f32 v[172:173], v[172:173], v[188:189] op_sel:[0,0] op_sel_hi:[1,1]
    v_rcp_f32 v191, v191
    v_cvt_pk_bf16_f32 v170, v172, v173
    v_pk_mul_f32 v[174:175], v[174:175], v[190:191] op_sel:[0,0] op_sel_hi:[1,1]
    v_cvt_pk_bf16_f32 v171, v174, v175
    v_permlane32_swap_b32 v168, v170
    buffer_load_dwordx2 a[54:55], v62, s[16:19], s3 offen offset:1288 sc1
    v_permlane32_swap_b32 v169, v171
    buffer_load_dwordx4 a[56:59], v62, s[16:19], s54 offen offset:2048 sc1
    buffer_store_dwordx4 v[168:171], v6, s[16:19], s51 offen sc1
    v_pk_fma_f32 v[64:65], v[44:45], v[120:121], v[64:65] op_sel:[0,0,0] op_sel_hi:[0,1,1]
    v_pk_fma_f32 v[66:67], v[44:45], v[122:123], v[66:67] op_sel:[0,0,0] op_sel_hi:[0,1,1]
    s_waitcnt lgkmcnt(0)
    v_pk_fma_f32 v[80:81], v[44:45], v[32:33], v[80:81] op_sel:[0,0,0] op_sel_hi:[0,1,1]
    v_pk_fma_f32 v[82:83], v[44:45], v[34:35], v[82:83] op_sel:[0,0,0] op_sel_hi:[0,1,1]
    v_cndmask_b32 v56, v64, v80, s[82:83]
    buffer_load_dwordx4 v[144:147], v62, s[16:19], s54 offen offset:3072 sc1
    v_cndmask_b32 v57, v65, v81, s[82:83]
    v_cndmask_b32 v58, v66, v82, s[82:83]
    v_cndmask_b32 v59, v67, v83, s[82:83]
    v_pk_mul_f32 v[56:57], v[48:49], v[56:57] op_sel:[0,0] op_sel_hi:[0,1]
    v_pk_mul_f32 v[58:59], v[48:49], v[58:59] op_sel:[0,0] op_sel_hi:[0,1]
    v_exp_f32 v56, v56
    v_exp_f32 v57, v57
    buffer_load_dwordx4 v[240:243], v119, s[16:19], s54 offen offset:0 sc1
    v_pk_mul_f32 v[64:65], v[64:65], v[80:81] op_sel:[0,0] op_sel_hi:[1,1]
    v_exp_f32 v58, v58
    v_exp_f32 v59, v59
    v_pk_mul_f32 v[66:67], v[66:67], v[82:83] op_sel:[0,0] op_sel_hi:[1,1]
    v_pk_fma_f32 v[80:81], v[56:57], v[52:53], v[52:53] op_sel:[0,0,0] op_sel_hi:[1,0,0]
    v_rcp_f32 v80, v80
    buffer_load_dwordx4 v[244:247], v62, s[16:19], s55 offen offset:0 sc1
    v_pk_fma_f32 v[82:83], v[58:59], v[52:53], v[52:53] op_sel:[0,0,0] op_sel_hi:[1,0,0]
    v_rcp_f32 v81, v81
    v_rcp_f32 v82, v82
    v_rcp_f32 v83, v83
    v_pk_mul_f32 v[64:65], v[64:65], v[80:81] op_sel:[0,0] op_sel_hi:[1,1]
    v_pk_mul_f32 v[66:67], v[66:67], v[82:83] op_sel:[0,0] op_sel_hi:[1,1]
    buffer_load_dwordx4 v[248:251], v62, s[16:19], s55 offen offset:1024 sc1
    v_cvt_pk_bf16_f32 v64, v64, v65
    v_cvt_pk_bf16_f32 v65, v66, v67
    v_pk_fma_f32 v[68:69], v[44:45], v[120:121], v[68:69] op_sel:[1,0,0] op_sel_hi:[1,1,1]
    v_pk_fma_f32 v[70:71], v[44:45], v[122:123], v[70:71] op_sel:[1,0,0] op_sel_hi:[1,1,1]
    v_pk_fma_f32 v[84:85], v[44:45], v[32:33], v[84:85] op_sel:[1,0,0] op_sel_hi:[1,1,1]
    v_pk_fma_f32 v[86:87], v[44:45], v[34:35], v[86:87] op_sel:[1,0,0] op_sel_hi:[1,1,1]
    v_cndmask_b32 v56, v68, v84, s[82:83]
    v_cndmask_b32 v57, v69, v85, s[82:83]
    v_cndmask_b32 v58, v70, v86, s[82:83]
    buffer_load_dwordx4 v[252:255], v62, s[16:19], s55 offen offset:2048 sc1
    v_cndmask_b32 v59, v71, v87, s[82:83]
    v_pk_mul_f32 v[56:57], v[48:49], v[56:57] op_sel:[1,0] op_sel_hi:[1,1]
    v_exp_f32 v56, v56
    v_pk_mul_f32 v[58:59], v[48:49], v[58:59] op_sel:[1,0] op_sel_hi:[1,1]
    v_exp_f32 v57, v57
    v_exp_f32 v58, v58
    buffer_load_dwordx4 a[192:195], v62, s[16:19], s55 offen offset:3072 sc1
    v_pk_mul_f32 v[68:69], v[68:69], v[84:85] op_sel:[0,0] op_sel_hi:[1,1]
    v_exp_f32 v59, v59
    v_pk_mul_f32 v[70:71], v[70:71], v[86:87] op_sel:[0,0] op_sel_hi:[1,1]
    v_pk_fma_f32 v[84:85], v[56:57], v[52:53], v[52:53] op_sel:[0,1,1] op_sel_hi:[1,1,1]
    v_rcp_f32 v84, v84
    v_rcp_f32 v85, v85
    buffer_load_dwordx4 a[60:63], v119, s[16:19], s55 offen offset:0 sc1
    v_pk_fma_f32 v[86:87], v[58:59], v[52:53], v[52:53] op_sel:[0,1,1] op_sel_hi:[1,1,1]
    s_xor_b32 s51, s57, 0
    v_rcp_f32 v86, v86
    v_pk_mul_f32 v[68:69], v[68:69], v[84:85] op_sel:[0,0] op_sel_hi:[1,1]
    v_rcp_f32 v87, v87
    v_cvt_pk_bf16_f32 v66, v68, v69
    v_pk_mul_f32 v[70:71], v[70:71], v[86:87] op_sel:[0,0] op_sel_hi:[1,1]
    buffer_load_dwordx4 a[64:67], v62, s[16:19], s4 offen offset:0 sc1
    v_cvt_pk_bf16_f32 v67, v70, v71
    v_permlane32_swap_b32 v64, v66
    v_pk_fma_f32 v[72:73], v[46:47], v[120:121], v[72:73] op_sel:[0,0,0] op_sel_hi:[0,1,1]
    v_pk_fma_f32 v[74:75], v[46:47], v[122:123], v[74:75] op_sel:[0,0,0] op_sel_hi:[0,1,1]
    v_permlane32_swap_b32 v65, v67
    v_pk_fma_f32 v[88:89], v[46:47], v[32:33], v[88:89] op_sel:[0,0,0] op_sel_hi:[0,1,1]
    v_pk_fma_f32 v[90:91], v[46:47], v[34:35], v[90:91] op_sel:[0,0,0] op_sel_hi:[0,1,1]
    buffer_load_dwordx4 a[68:71], v62, s[16:19], s4 offen offset:1024 sc1
    v_cndmask_b32 v56, v72, v88, s[82:83]
    buffer_store_dwordx4 v[64:67], v6, s[16:19], s51 offen sc1
    v_cndmask_b32 v57, v73, v89, s[82:83]
    v_cndmask_b32 v58, v74, v90, s[82:83]
    v_cndmask_b32 v59, v75, v91, s[82:83]
    v_pk_mul_f32 v[56:57], v[50:51], v[56:57] op_sel:[0,0] op_sel_hi:[0,1]
    v_pk_mul_f32 v[58:59], v[50:51], v[58:59] op_sel:[0,0] op_sel_hi:[0,1]
    buffer_load_dwordx4 a[72:75], v62, s[16:19], s4 offen offset:2048 sc1
    v_pk_mul_f32 v[72:73], v[72:73], v[88:89] op_sel:[0,0] op_sel_hi:[1,1]
    v_exp_f32 v56, v56
    v_exp_f32 v57, v57
    v_exp_f32 v58, v58
    v_exp_f32 v59, v59
    buffer_load_dwordx4 a[76:79], v62, s[16:19], s4 offen offset:3072 sc1
    v_pk_mul_f32 v[74:75], v[74:75], v[90:91] op_sel:[0,0] op_sel_hi:[1,1]
    buffer_load_dword v124, v126, s[16:19], s71 offen sc1
    v_pk_fma_f32 v[88:89], v[56:57], v[54:55], v[54:55] op_sel:[0,0,0] op_sel_hi:[1,0,0]
    v_rcp_f32 v88, v88
    v_rcp_f32 v89, v89
    s_add_u32 s69, s69, 65536
    s_waitcnt vmcnt(13)
    buffer_store_byte v116, v5, s[16:19], s69 offen sc1
    v_pk_fma_f32 v[90:91], v[58:59], v[54:55], v[54:55] op_sel:[0,0,0] op_sel_hi:[1,0,0]
    v_rcp_f32 v90, v90
    v_pk_mul_f32 v[72:73], v[72:73], v[88:89] op_sel:[0,0] op_sel_hi:[1,1]
    buffer_load_dwordx4 a[80:83], v119, s[16:19], s4 offen offset:0 sc1
    v_cvt_pk_bf16_f32 v72, v72, v73
    v_rcp_f32 v91, v91
    v_pk_fma_f32 v[76:77], v[46:47], v[120:121], v[76:77] op_sel:[1,0,0] op_sel_hi:[1,1,1]
    v_pk_mul_f32 v[74:75], v[74:75], v[90:91] op_sel:[0,0] op_sel_hi:[1,1]
    v_cvt_pk_bf16_f32 v73, v74, v75
    v_pk_fma_f32 v[78:79], v[46:47], v[122:123], v[78:79] op_sel:[1,0,0] op_sel_hi:[1,1,1]
    v_pk_fma_f32 v[92:93], v[46:47], v[32:33], v[92:93] op_sel:[1,0,0] op_sel_hi:[1,1,1]
    v_pk_fma_f32 v[94:95], v[46:47], v[34:35], v[94:95] op_sel:[1,0,0] op_sel_hi:[1,1,1]
    buffer_load_dwordx4 a[84:87], v62, s[16:19], s5 offen offset:0 sc1
    v_cndmask_b32 v56, v76, v92, s[82:83]
    v_cndmask_b32 v57, v77, v93, s[82:83]
    v_cndmask_b32 v58, v78, v94, s[82:83]
    v_cndmask_b32 v59, v79, v95, s[82:83]
    v_pk_mul_f32 v[56:57], v[50:51], v[56:57] op_sel:[1,0] op_sel_hi:[1,1]
    v_exp_f32 v56, v56
    v_exp_f32 v57, v57
    buffer_load_dwordx4 a[88:91], v62, s[16:19], s5 offen offset:1024 sc1
    v_pk_mul_f32 v[58:59], v[50:51], v[58:59] op_sel:[1,0] op_sel_hi:[1,1]
    v_exp_f32 v58, v58
    v_exp_f32 v59, v59
    v_pk_mul_f32 v[76:77], v[76:77], v[92:93] op_sel:[0,0] op_sel_hi:[1,1]
    v_pk_mul_f32 v[78:79], v[78:79], v[94:95] op_sel:[0,0] op_sel_hi:[1,1]
    v_pk_fma_f32 v[92:93], v[56:57], v[54:55], v[54:55] op_sel:[0,1,1] op_sel_hi:[1,1,1]
    v_pk_fma_f32 v[94:95], v[58:59], v[54:55], v[54:55] op_sel:[0,1,1] op_sel_hi:[1,1,1]
    buffer_load_dwordx4 a[92:95], v62, s[16:19], s5 offen offset:2048 sc1
    v_rcp_f32 v92, v92
    v_rcp_f32 v93, v93
    s_xor_b32 s51, s57, 2048
    v_rcp_f32 v94, v94
    v_pk_mul_f32 v[76:77], v[76:77], v[92:93] op_sel:[0,0] op_sel_hi:[1,1]
    buffer_load_dwordx4 a[96:99], v62, s[16:19], s5 offen offset:3072 sc1
    v_cvt_pk_bf16_f32 v74, v76, v77
    v_rcp_f32 v95, v95
    s_nop 0
    v_pk_mul_f32 v[78:79], v[78:79], v[94:95] op_sel:[0,0] op_sel_hi:[1,1]
    v_cvt_pk_bf16_f32 v75, v78, v79
    v_permlane32_swap_b32 v72, v74
    s_nop 0
    v_permlane32_swap_b32 v73, v75
    buffer_load_dwordx4 a[100:103], v119, s[16:19], s5 offen offset:0 sc1
    buffer_store_dwordx4 v[72:75], v6, s[16:19], s51 offen sc1
    s_add_u32 s51, s41, 16384
    v_add_u32 v56, s51, v62
    v_lshl_add_u32 v57, v0, 3, s51
    v_lshrrev_b32 v176, 2, v0
    buffer_load_dwordx4 a[104:107], v62, s[16:19], s6 offen offset:0 sc1
    v_and_b32 v177, 3, v0
    v_lshl_add_u32 v59, v176, 4, s51
    v_lshl_add_u32 v58, v177, 8, v59
    v_lshl_add_u32 v4, v176, 3, s51
    v_lshl_add_u32 v3, v177, 7, v4
    ds_write_b128 v56, a[196:199] offset:0
    ds_write_b128 v56, a[200:203] offset:1024
    ds_write_b128 v56, a[204:207] offset:2048
    ds_write_b64 v57, a[208:209] offset:2560
    ds_write_b64 v57, a[210:211] offset:3072
    ds_write_b64 v57, a[212:213] offset:3584
    buffer_load_dwordx4 a[108:111], v62, s[16:19], s6 offen offset:1024 sc1
    v_mov_b32 v176, 0xf149f2ca
    v_cndmask_b32 v184, v176, 0, s[24:25]
    v_cndmask_b32 v185, v176, 0, s[26:27]
    v_cndmask_b32 v188, v176, 0, s[28:29]
    v_cndmask_b32 v189, v176, 0, s[30:31]
    v_cndmask_b32 v48, v176, v188, s[84:85]
    v_cndmask_b32 v49, v176, v189, s[84:85]
    v_cndmask_b32 v186, v176, 0, s[12:13]
    v_cndmask_b32 v187, v176, 0, s[14:15]
    buffer_load_dwordx4 a[112:115], v62, s[16:19], s6 offen offset:2048 sc1
    v_cndmask_b32 v190, v176, 0, s[20:21]
    v_cndmask_b32 v191, v176, 0, s[22:23]
    v_cndmask_b32 v50, v176, v190, s[84:85]
    v_cndmask_b32 v51, v176, v191, s[84:85]
    v_mfma_f32_16x16x16_bf16 v[64:67], a[40:41], a[216:217], v[184:187]
    ds_read_b64_tr_b16 a[232:233], v3 offset:2560
    v_mfma_f32_16x16x16_bf16 v[68:71], a[52:53], a[216:217], v[48:51]
    ds_read_b64_tr_b16 a[234:235], v58 offset:0
    v_mfma_f32_16x16x16_bf16 v[72:75], a[42:43], a[218:219], v[184:187]
    ds_read_b64_tr_b16 a[236:237], v58 offset:8
    buffer_load_dwordx4 a[116:119], v62, s[16:19], s6 offen offset:3072 sc1
    v_mfma_f32_16x16x16_bf16 v[76:79], a[40:41], a[218:219], v[188:191]
    ds_read_b64_tr_b16 a[238:239], v4 offset:3072
    v_mfma_f32_16x16x16_bf16 v[80:83], a[48:49], a[220:221], v[184:187]
    ds_read_b64_tr_b16 a[240:241], v59 offset:1024
    v_mfma_f32_16x16x16_bf16 v[84:87], a[54:55], a[220:221], v[48:51]
    s_xor_b32 s0, s78, 0
    ds_read_b64_tr_b16 a[242:243], v59 offset:1032
    buffer_load_dwordx4 a[40:43], v119, s[16:19], s6 offen offset:0 sc1
    v_mfma_f32_16x16x16_bf16 v[88:91], a[50:51], a[222:223], v[184:187]
    ds_read_b64_tr_b16 a[244:245], v3 offset:3200
    v_mfma_f32_16x16x16_bf16 v[92:95], a[48:49], a[222:223], v[188:191]
    ds_read_b64_tr_b16 a[246:247], v58 offset:1280
    v_mfma_f32_16x16x16_bf16 v[64:67], a[204:205], a[224:225], v[64:67]
    ds_read_b64_tr_b16 a[248:249], v58 offset:1288
    buffer_load_dwordx4 a[52:55], v62, s[16:19], s7 offen offset:0 sc1
    v_mfma_f32_16x16x16_bf16 v[68:71], a[212:213], a[224:225], v[68:71]
    s_waitcnt vmcnt(14)
    ds_read_b64_tr_b16 a[250:251], v4 offset:3712
    v_cmp_ne_u32 vcc, 0x101, v124
    v_mfma_f32_16x16x16_bf16 v[72:75], a[206:207], a[226:227], v[72:75]
    s_cbranch_vccnz K_slow2
K_back2:
    ds_read_b64_tr_b16 a[252:253], v59 offset:2304
    v_mfma_f32_16x16x16_bf16 v[76:79], a[204:205], a[226:227], v[76:79]
    ds_read_b64_tr_b16 a[254:255], v59 offset:2312
    buffer_load_dwordx4 v[120:123], v62, s[16:19], s0 offen sc1
    v_mfma_f32_16x16x16_bf16 v[80:83], a[204:205], a[228:229], v[80:83]
    s_xor_b32 s0, s78, 1024
    v_and_b32 v160, 16, v62
    v_mfma_f32_16x16x16_bf16 v[84:87], a[212:213], a[228:229], v[84:87]
    v_mov_b32 v161, 0xffff
    v_mfma_f32_16x16x16_bf16 v[88:91], a[206:207], a[230:231], v[88:91]
    buffer_load_dwordx4 a[48:51], v62, s[16:19], s0 offen sc1
    v_lshlrev_b32 v161, v160, v161
    v_mfma_f32_16x16x16_bf16 v[92:95], a[204:205], a[230:231], v[92:95]
    s_xor_b32 s0, s78, 2048
    v_subrev_u32 v60, 256, v60
    v_max3_f32 v176, v64, v65, v68
    v_max3_f32 v177, v66, v67, v70
    v_max_f32 v176, v176, v69
    v_max_f32 v177, v177, v71
    v_max_f32 v64, v176, v177
    buffer_load_dwordx4 a[120:123], v62, s[16:19], s0 offen sc1
    v_max3_f32 v178, v72, v73, v76
    v_max3_f32 v179, v74, v75, v78
    v_max_f32 v178, v178, v77
    v_max_f32 v179, v179, v79
    s_xor_b32 s0, s78, 3072
    v_max_f32 v72, v178, v179
    v_max3_f32 v180, v80, v81, v84
    v_max3_f32 v181, v82, v83, v86
    v_max_f32 v180, v180, v85
    v_max_f32 v181, v181, v87
    v_max_f32 v80, v180, v181
    v_max3_f32 v182, v88, v89, v92
    v_max3_f32 v183, v90, v91, v94
    v_max_f32 v182, v182, v93
    v_max_f32 v183, v183, v95
    v_max_f32 v88, v182, v183
    v_permlane32_swap_b32 v64, v72
    buffer_load_dwordx4 a[124:127], v62, s[16:19], s0 offen sc1
    v_permlane32_swap_b32 v80, v88
    v_max_f32 v64, v64, v72
    v_max_f32 v80, v80, v88
    s_xor_b32 s0, s78, 8192
    v_cndmask_b32 v52, 0, v161, s[32:33]
    v_cndmask_b32 v54, v161, 0, s[32:33]
    v_permlane16_swap_b32 v64, v80
    v_max_f32 v64, v64, v80
    v_mov_b32 v80, v64
    v_cndmask_b32 v53, 0, v161, s[52:53]
    v_cndmask_b32 v55, v161, 0, s[52:53]
    buffer_load_dwordx4 a[128:131], v62, s[16:19], s0 offen sc1
    v_permlane16_swap_b32 v64, v80
    v_mov_b32 v72, v64
    v_mov_b32 v88, v80
    s_xor_b32 s0, s78, 9216
    v_min_u32 v60, v118, v60
    v_permlane32_swap_b32 v64, v72
    v_permlane32_swap_b32 v80, v88
    v_pk_add_f32 v[176:177], v[176:177], v[64:65] op_sel:[0,0] op_sel_hi:[1,0] neg_lo:[0,1] neg_hi:[0,1]
    v_pk_add_f32 v[178:179], v[178:179], v[72:73] op_sel:[0,0] op_sel_hi:[1,0] neg_lo:[0,1] neg_hi:[0,1]
    v_pk_add_f32 v[180:181], v[180:181], v[80:81] op_sel:[0,0] op_sel_hi:[1,0] neg_lo:[0,1] neg_hi:[0,1]
    v_pk_add_f32 v[182:183], v[182:183], v[88:89] op_sel:[0,0] op_sel_hi:[1,0] neg_lo:[0,1] neg_hi:[0,1]
    buffer_load_dwordx4 a[132:135], v62, s[16:19], s0 offen sc1
    v_exp_f32 v176, v176
    v_exp_f32 v177, v177
    s_xor_b32 s0, s78, 10240
    v_exp_f32 v178, v178
    v_exp_f32 v179, v179
    v_exp_f32 v180, v180
    v_exp_f32 v181, v181
    s_add_u32 s69, s69, 65536
    s_waitcnt vmcnt(12)
    v_exp_f32 v182, v182
    v_exp_f32 v183, v183
    buffer_store_byte v116, v5, s[16:19], s69 offen sc1
    v_cvt_pk_bf16_f32 v176, v176, v176
    v_cvt_pk_bf16_f32 v177, v177, v177
    v_cvt_pk_bf16_f32 v178, v178, v178
    v_cvt_pk_bf16_f32 v179, v179, v179
    buffer_load_dwordx4 a[136:139], v62, s[16:19], s0 offen sc1
    v_cvt_pk_bf16_f32 v180, v180, v180
    v_cvt_pk_bf16_f32 v181, v181, v181
    v_cvt_pk_bf16_f32 v182, v182, v182
    v_cvt_pk_bf16_f32 v183, v183, v183
    s_xor_b32 s0, s78, 11264
    v_and_b32 v160, v54, v176
    v_and_b32 v162, v52, v176
    v_and_b32 v161, v55, v177
    v_and_b32 v163, v53, v177
    v_and_b32 v164, v54, v178
    v_and_b32 v166, v52, v178
    v_and_b32 v165, v55, v179
    v_and_b32 v167, v53, v179
    v_mfma_f32_16x16x32_bf16 v[8:11], v[24:27], v[160:163], 0
    buffer_load_dwordx4 a[140:143], v62, s[16:19], s0 offen sc1
    v_and_b32 v168, v54, v180
    v_and_b32 v170, v52, v180
    s_xor_b32 s0, s78, 16384
    v_and_b32 v169, v55, v181
    v_and_b32 v171, v53, v181
    v_mfma_f32_16x16x32_bf16 v[12:15], v[24:27], v[164:167], 0
    v_and_b32 v172, v54, v182
    v_and_b32 v174, v52, v182
    buffer_load_dwordx4 a[144:147], v62, s[16:19], s0 offen sc1
    v_and_b32 v173, v55, v183
    v_and_b32 v175, v53, v183
    v_mfma_f32_16x16x32_bf16 v[16:19], v[24:27], v[168:171], 0
    s_waitcnt lgkmcnt(10)
    s_xor_b32 s0, s78, 17408
    v_mfma_f32_16x16x32_bf16 v[64:67], a[232:235], v[160:163], 0
    v_mfma_f32_16x16x32_bf16 v[20:23], v[24:27], v[172:175], 0
    s_waitcnt lgkmcnt(7)
    buffer_load_dwordx4 a[148:151], v62, s[16:19], s0 offen sc1
    v_mfma_f32_16x16x32_bf16 v[68:71], a[238:241], v[160:163], 0
    s_waitcnt lgkmcnt(4)
    s_xor_b32 s0, s78, 18432
    v_mfma_f32_16x16x32_bf16 v[80:83], a[244:247], v[168:171], 0
    s_waitcnt lgkmcnt(1)
    v_rcp_f32 v8, v8
    v_mfma_f32_16x16x32_bf16 v[84:87], a[250:253], v[168:171], 0
    buffer_load_dwordx4 a[152:155], v62, s[16:19], s0 offen sc1
    v_mfma_f32_16x16x32_bf16 v[72:75], a[234:237], v[164:167], 0
    s_xor_b32 s0, s78, 19456
    v_rcp_f32 v16, v16
    v_mfma_f32_16x16x32_bf16 v[76:79], a[240:243], v[164:167], 0
    v_mfma_f32_16x16x32_bf16 v[88:91], a[246:249], v[172:175], 0
    s_waitcnt lgkmcnt(0)
    buffer_load_dwordx4 a[156:159], v62, s[16:19], s0 offen sc1
    v_rcp_f32 v12, v12
    v_mfma_f32_16x16x32_bf16 v[92:95], a[252:255], v[172:175], 0
    s_xor_b32 s0, s78, 24576
    v_rcp_f32 v20, v20
    v_pk_mul_f32 v[64:65], v[8:9], v[64:65] op_sel:[0,0] op_sel_hi:[0,1]
    v_pk_mul_f32 v[66:67], v[8:9], v[66:67] op_sel:[0,0] op_sel_hi:[0,1]
    v_pk_mul_f32 v[68:69], v[8:9], v[68:69] op_sel:[0,0] op_sel_hi:[0,1]
    v_pk_mul_f32 v[70:71], v[8:9], v[70:71] op_sel:[0,0] op_sel_hi:[0,1]
    s_add_u32 s71, s71, 65536
    s_buffer_load_dword s42, s[16:19], s71 offset:0
    v_cvt_pk_bf16_f32 v184, v64, v65
    v_cvt_pk_bf16_f32 v185, v66, v67
    v_pk_mul_f32 v[80:81], v[16:17], v[80:81] op_sel:[0,0] op_sel_hi:[0,1]
    v_pk_mul_f32 v[82:83], v[16:17], v[82:83] op_sel:[0,0] op_sel_hi:[0,1]
    s_buffer_load_dword s43, s[16:19], s71 offset:128
    s_buffer_load_dword s44, s[16:19], s71 offset:256
    v_pk_mul_f32 v[84:85], v[16:17], v[84:85] op_sel:[0,0] op_sel_hi:[0,1]
    v_pk_mul_f32 v[86:87], v[16:17], v[86:87] op_sel:[0,0] op_sel_hi:[0,1]
    v_cvt_pk_bf16_f32 v186, v80, v81
    v_cvt_pk_bf16_f32 v187, v82, v83
    s_buffer_load_dword s45, s[16:19], s71 offset:384
    buffer_store_dwordx4 v[184:187], v62, s[16:19], s66 offen offset:0 sc1
    v_pk_mul_f32 v[72:73], v[12:13], v[72:73] op_sel:[0,0] op_sel_hi:[0,1]
    buffer_load_dwordx4 a[160:163], v62, s[16:19], s0 offen sc1
    v_pk_mul_f32 v[74:75], v[12:13], v[74:75] op_sel:[0,0] op_sel_hi:[0,1]
    v_cvt_pk_bf16_f32 v48, v72, v73
    v_cvt_pk_bf16_f32 v49, v74, v75
    v_mul_f32_dpp v68, v76, v12 quad_perm:[0,1,2,3] row_mask:0x8 bank_mask:0xf
    v_mul_f32_dpp v69, v77, v12 quad_perm:[0,1,2,3] row_mask:0x8 bank_mask:0xf
    v_mul_f32_dpp v70, v78, v12 quad_perm:[0,1,2,3] row_mask:0x8 bank_mask:0xf
    v_mul_f32_dpp v71, v79, v12 quad_perm:[0,1,2,3] row_mask:0x8 bank_mask:0xf
    v_cvt_pk_bf16_f32 v188, v68, v69
    v_cvt_pk_bf16_f32 v189, v70, v71
    v_pk_mul_f32 v[88:89], v[20:21], v[88:89] op_sel:[0,0] op_sel_hi:[0,1]
    v_pk_mul_f32 v[90:91], v[20:21], v[90:91] op_sel:[0,0] op_sel_hi:[0,1]
    v_cvt_pk_bf16_f32 v50, v88, v89
    v_cvt_pk_bf16_f32 v51, v90, v91
    buffer_store_dwordx4 v[48:51], v62, s[16:19], s66 offen offset:1024 sc1
    v_mul_f32_dpp v84, v92, v20 quad_perm:[0,1,2,3] row_mask:0x8 bank_mask:0xf
    v_mul_f32_dpp v85, v93, v20 quad_perm:[0,1,2,3] row_mask:0x8 bank_mask:0xf
    v_mul_f32_dpp v86, v94, v20 quad_perm:[0,1,2,3] row_mask:0x8 bank_mask:0xf
    v_mul_f32_dpp v87, v95, v20 quad_perm:[0,1,2,3] row_mask:0x8 bank_mask:0xf
    v_cvt_pk_bf16_f32 v190, v84, v85
    v_cvt_pk_bf16_f32 v191, v86, v87
    buffer_store_dwordx4 v[188:191], v60, s[16:19], s67 offen sc1
    s_waitcnt vmcnt(16)
    v_mfma_f32_16x16x32_bf16 v[28:31], v[96:99], v[120:123], 0
    s_waitcnt vmcnt(15)
    v_mfma_f32_16x16x32_bf16 a[196:199], v[96:99], a[48:51], 0
    s_waitcnt vmcnt(14)
    s_mul_i32 s51, s46, 3072
    v_and_b32 v8, 15, v0
    v_lshrrev_b32 v9, 4, v0
    v_mfma_f32_16x16x32_bf16 a[216:219], v[96:99], a[120:123], 0
    s_waitcnt vmcnt(13)
    s_add_u32 s51, s51, 147456
    v_mul_u32_u24 v8, 160, v8
    v_lshlrev_b32 v9, 3, v9
    v_mfma_f32_16x16x32_bf16 a[236:239], v[96:99], a[124:127], 0
    s_xor_b32 s0, s78, 25600
    v_add3_u32 v4, v8, v9, s51
    v_mfma_f32_16x16x32_bf16 a[240:243], v[100:103], a[124:127], 0
    s_lshl_b32 s51, s46, 10
    v_add_u32 v6, s51, v62
    v_xor_b32 v7, 1024, v6
    v_mfma_f32_16x16x32_bf16 a[220:223], v[100:103], a[120:123], 0
    s_mov_b32 s58, 0x3fb8aa3b
    v_xor_b32 v63, 2048, v6
    v_xor_b32 v3, 3072, v6
    v_mfma_f32_16x16x32_bf16 a[200:203], v[100:103], a[48:51], 0
    ds_read_b64 v[48:49], v4 offset:0
    ds_read_b64 v[50:51], v4 offset:32
    v_mfma_f32_16x16x32_bf16 v[32:35], v[100:103], v[120:123], 0
    ds_read_b64 v[52:53], v4 offset:64
    ds_read_b64 v[54:55], v4 offset:96
    v_mfma_f32_16x16x32_bf16 v[36:39], v[104:107], v[120:123], 0
    ds_read_b64 v[56:57], v4 offset:128
    v_mfma_f32_16x16x32_bf16 a[204:207], v[104:107], a[48:51], 0
    buffer_load_dwordx4 v[96:99], v62, s[16:19], s0 offen sc1
    v_mfma_f32_16x16x32_bf16 a[224:227], v[104:107], a[120:123], 0
    s_xor_b32 s0, s78, 26624
    v_mfma_f32_16x16x32_bf16 a[244:247], v[104:107], a[124:127], 0
    v_mfma_f32_16x16x32_bf16 a[248:251], v[108:111], a[124:127], 0
    v_mfma_f32_16x16x32_bf16 a[228:231], v[108:111], a[120:123], 0
    buffer_load_dwordx4 v[100:103], v62, s[16:19], s0 offen sc1
    v_mfma_f32_16x16x32_bf16 a[208:211], v[108:111], a[48:51], 0
    s_xor_b32 s0, s78, 27648
    v_mfma_f32_16x16x32_bf16 v[40:43], v[108:111], v[120:123], 0
    v_mfma_f32_16x16x32_bf16 v[44:47], v[112:115], v[120:123], 0
    v_mfma_f32_16x16x32_bf16 a[212:215], v[112:115], a[48:51], 0
    buffer_load_dwordx4 v[104:107], v62, s[16:19], s0 offen sc1
    v_mfma_f32_16x16x32_bf16 a[232:235], v[112:115], a[120:123], 0
    s_mul_i32 s51, s46, 3072
    s_add_u32 s51, s51, 147456
    v_lshrrev_b32 v8, 4, v62
    v_mfma_f32_16x16x32_bf16 a[252:255], v[112:115], a[124:127], 0
    s_waitcnt vmcnt(15)
    v_and_b32 v9, 4, v8
    v_lshl_add_u32 v9, v9, 3, v8
    v_mfma_f32_16x16x32_bf16 v[28:31], v[204:207], a[128:131], v[28:31]
    s_waitcnt vmcnt(14)
    v_bfe_u32 v9, v9, 4, 2
    v_lshl_add_u32 v9, v9, 3, s51
    v_mfma_f32_16x16x32_bf16 a[196:199], v[204:207], a[132:135], a[196:199]
    s_waitcnt vmcnt(12)
    buffer_load_dwordx4 a[48:51], v62, s[16:19], s7 offen offset:1024 sc1
    v_mfma_f32_16x16x32_bf16 a[216:219], v[204:207], a[136:139], a[216:219]
    s_waitcnt vmcnt(12)
    v_and_b32 v10, 15, v8
    v_lshl_add_u32 v4, v10, 5, v9
    v_mfma_f32_16x16x32_bf16 a[236:239], v[204:207], a[140:143], a[236:239]
    v_xor_b32 v9, v8, v62
    v_and_b32 v9, 16, v9
    v_mfma_f32_16x16x32_bf16 a[240:243], v[192:195], a[140:143], a[240:243]
    v_bfe_u32 v10, v8, 1, 1
    v_mul_u32_u24 v10, 640, v10
    v_mfma_f32_16x16x32_bf16 a[220:223], v[192:195], a[136:139], a[220:223]
    s_waitcnt lgkmcnt(0)
    s_and_b64 s[42:43], s[42:43], s[44:45]
    s_and_b32 s42, s42, s43
    v_add3_u32 v9, v9, v10, s51
    v_mfma_f32_16x16x32_bf16 a[200:203], v[192:195], a[132:135], a[200:203]
    s_andn2_b64 vcc, 0x101, s[42:43]
    s_cbranch_vccnz K_slow3
K_back3:
    v_lshrrev_b32 v8, 2, v8
    v_mfma_f32_16x16x32_bf16 v[32:35], v[192:195], a[128:131], v[32:35]
    buffer_load_dwordx4 v[204:207], v62, s[16:19], s7 offen offset:2048 sc1
    v_mfma_f32_16x16x32_bf16 v[36:39], v[196:199], a[128:131], v[36:39]
    s_xor_b32 s0, s78, 4096
    v_lshl_add_u32 v2, v8, 5, v9
    v_mul_u32_u24 v8, 1280, v8
    v_mfma_f32_16x16x32_bf16 a[204:207], v[196:199], a[132:135], a[204:207]
    v_and_or_b32 v1, v62, 48, v8
    v_lshlrev_b32 v8, 16, v48
    v_mfma_f32_16x16x32_bf16 a[224:227], v[196:199], a[136:139], a[224:227]
    v_and_b32 v9, 0xffff0000, v48
    v_lshlrev_b32 v10, 16, v49
    v_mfma_f32_16x16x32_bf16 a[244:247], v[196:199], a[140:143], a[244:247]
    buffer_load_dwordx4 v[108:111], v62, s[16:19], s0 offen sc1
    v_mfma_f32_16x16x32_bf16 a[248:251], v[200:203], a[140:143], a[248:251]
    s_xor_b32 s0, s78, 5120
    v_and_b32 v11, 0xffff0000, v49
    v_lshlrev_b32 v12, 16, v50
    v_mfma_f32_16x16x32_bf16 a[228:231], v[200:203], a[136:139], a[228:231]
    v_and_b32 v13, 0xffff0000, v50
    v_lshlrev_b32 v14, 16, v51
    v_mfma_f32_16x16x32_bf16 a[208:211], v[200:203], a[132:135], a[208:211]
    v_and_b32 v15, 0xffff0000, v51
    v_lshlrev_b32 v16, 16, v52
    v_mfma_f32_16x16x32_bf16 v[40:43], v[200:203], a[128:131], v[40:43]
    buffer_load_dwordx4 v[112:115], v62, s[16:19], s0 offen sc1
    v_mfma_f32_16x16x32_bf16 v[44:47], v[208:211], a[128:131], v[44:47]
    s_xor_b32 s0, s78, 6144
    v_and_b32 v17, 0xffff0000, v52
    v_lshlrev_b32 v18, 16, v53
    v_mfma_f32_16x16x32_bf16 a[212:215], v[208:211], a[132:135], a[212:215]
    v_and_b32 v19, 0xffff0000, v53
    v_lshlrev_b32 v20, 16, v54
    v_mfma_f32_16x16x32_bf16 a[232:235], v[208:211], a[136:139], a[232:235]
    v_and_b32 v21, 0xffff0000, v54
    v_lshlrev_b32 v22, 16, v55
    v_mfma_f32_16x16x32_bf16 a[252:255], v[208:211], a[140:143], a[252:255]
    s_waitcnt vmcnt(14)
    buffer_load_dwordx4 v[120:123], v62, s[16:19], s0 offen sc1
    v_mfma_f32_16x16x32_bf16 v[28:31], v[212:215], a[144:147], v[28:31]
    s_waitcnt vmcnt(14)
    s_xor_b32 s0, s78, 7168
    v_and_b32 v23, 0xffff0000, v55
    v_mfma_f32_16x16x32_bf16 a[196:199], v[212:215], a[148:151], a[196:199]
    s_waitcnt vmcnt(13)
    v_lshlrev_b32 v24, 16, v56
    v_and_b32 v25, 0xffff0000, v56
    v_mfma_f32_16x16x32_bf16 a[216:219], v[212:215], a[152:155], a[216:219]
    s_waitcnt vmcnt(12)
    v_lshlrev_b32 v26, 16, v57
    v_and_b32 v27, 0xffff0000, v57
    v_mfma_f32_16x16x32_bf16 a[236:239], v[212:215], a[156:159], a[236:239]
    buffer_load_dwordx4 v[64:67], v62, s[16:19], s0 offen sc1
    v_mfma_f32_16x16x32_bf16 a[240:243], v[216:219], a[156:159], a[240:243]
    s_xor_b32 s0, s78, 12288
    v_mfma_f32_16x16x32_bf16 a[220:223], v[216:219], a[152:155], a[220:223]
    s_waitcnt vmcnt(9)
    s_mov_b32 s69, s1
    v_mfma_f32_16x16x32_bf16 a[200:203], v[216:219], a[148:151], a[200:203]
    buffer_store_byte v116, v5, s[16:19], s69 offen sc1
    v_mfma_f32_16x16x32_bf16 v[32:35], v[216:219], a[144:147], v[32:35]
    v_mfma_f32_16x16x32_bf16 v[36:39], v[220:223], a[144:147], v[36:39]
    buffer_load_dwordx4 v[68:71], v62, s[16:19], s0 offen sc1
    v_mfma_f32_16x16x32_bf16 a[204:207], v[220:223], a[148:151], a[204:207]
    s_barrier
    v_xor_b32 v58, 0x10000, v6
    v_xor_b32 v59, 0x10000, v7
    v_mfma_f32_16x16x32_bf16 a[224:227], v[220:223], a[152:155], a[224:227]
    s_xor_b32 s0, s78, 13312
    v_xor_b32 v61, 0x10000, v63
    v_xor_b32 v5, 0x10000, v3
    v_mfma_f32_16x16x32_bf16 a[244:247], v[220:223], a[156:159], a[244:247]
    v_add_u32 v0, 4096, v62
    v_mfma_f32_16x16x32_bf16 a[248:251], v[224:227], a[156:159], a[248:251]
    buffer_load_dwordx4 v[72:75], v62, s[16:19], s0 offen sc1
    v_mfma_f32_16x16x32_bf16 a[228:231], v[224:227], a[152:155], a[228:231]
    s_xor_b32 s0, s78, 14336
    v_mfma_f32_16x16x32_bf16 a[208:211], v[224:227], a[148:151], a[208:211]
    v_mfma_f32_16x16x32_bf16 v[40:43], v[224:227], a[144:147], v[40:43]
    v_mfma_f32_16x16x32_bf16 v[44:47], v[228:231], a[144:147], v[44:47]
    buffer_load_dwordx4 v[76:79], v62, s[16:19], s0 offen sc1
    v_mfma_f32_16x16x32_bf16 a[212:215], v[228:231], a[148:151], a[212:215]
    s_xor_b32 s0, s78, 15360
    v_mfma_f32_16x16x32_bf16 a[232:235], v[228:231], a[152:155], a[232:235]
    v_mfma_f32_16x16x32_bf16 a[252:255], v[228:231], a[156:159], a[252:255]
    v_mfma_f32_16x16x32_bf16 v[28:31], v[232:235], a[160:163], v[28:31]
    s_waitcnt vmcnt(12)
    buffer_load_dwordx4 v[80:83], v62, s[16:19], s0 offen sc1
    v_mfma_f32_16x16x32_bf16 a[196:199], v[232:235], v[96:99], a[196:199]
    s_waitcnt vmcnt(12)
    s_xor_b32 s0, s78, 20480
    v_mfma_f32_16x16x32_bf16 a[216:219], v[232:235], v[100:103], a[216:219]
    s_waitcnt vmcnt(11)
    v_mfma_f32_16x16x32_bf16 a[236:239], v[232:235], v[104:107], a[236:239]
    v_mfma_f32_16x16x32_bf16 a[240:243], v[236:239], v[104:107], a[240:243]
    buffer_load_dwordx4 v[84:87], v62, s[16:19], s0 offen sc1
    v_mfma_f32_16x16x32_bf16 a[220:223], v[236:239], v[100:103], a[220:223]
    s_xor_b32 s0, s78, 21504
    v_mfma_f32_16x16x32_bf16 a[200:203], v[236:239], v[96:99], a[200:203]
    v_mfma_f32_16x16x32_bf16 v[32:35], v[236:239], a[160:163], v[32:35]
    v_mfma_f32_16x16x32_bf16 v[36:39], v[128:131], a[160:163], v[36:39]
    buffer_load_dwordx4 v[88:91], v62, s[16:19], s0 offen sc1
    v_mfma_f32_16x16x32_bf16 a[204:207], v[128:131], v[96:99], a[204:207]
    s_xor_b32 s0, s78, 22528
    v_mfma_f32_16x16x32_bf16 a[224:227], v[128:131], v[100:103], a[224:227]
    v_mfma_f32_16x16x32_bf16 a[244:247], v[128:131], v[104:107], a[244:247]
    v_mfma_f32_16x16x32_bf16 a[248:251], v[132:135], v[104:107], a[248:251]
    buffer_load_dwordx4 v[92:95], v62, s[16:19], s0 offen sc1
    v_mfma_f32_16x16x32_bf16 a[228:231], v[132:135], v[100:103], a[228:231]
    s_xor_b32 s0, s78, 23552
    v_mfma_f32_16x16x32_bf16 a[208:211], v[132:135], v[96:99], a[208:211]
    v_mfma_f32_16x16x32_bf16 v[40:43], v[132:135], a[160:163], v[40:43]
    v_mfma_f32_16x16x32_bf16 v[44:47], v[136:139], a[160:163], v[44:47]
    buffer_load_dwordx4 v[128:131], v62, s[16:19], s0 offen sc1
    v_mfma_f32_16x16x32_bf16 a[212:215], v[136:139], v[96:99], a[212:215]
    s_xor_b32 s0, s78, 28672
    v_mfma_f32_16x16x32_bf16 a[232:235], v[136:139], v[100:103], a[232:235]
    v_mfma_f32_16x16x32_bf16 a[252:255], v[136:139], v[104:107], a[252:255]
    s_waitcnt vmcnt(12)
    v_mfma_f32_16x16x32_bf16 v[28:31], v[140:143], v[108:111], v[28:31]
    s_waitcnt vmcnt(11)
    s_add_u32 s71, s71, 65536
    s_buffer_load_dword s42, s[16:19], s71 offset:0
    v_mfma_f32_16x16x32_bf16 a[196:199], v[140:143], v[112:115], a[196:199]
    s_waitcnt vmcnt(10)
    s_buffer_load_dword s43, s[16:19], s71 offset:128
    s_buffer_load_dword s44, s[16:19], s71 offset:256
    v_mfma_f32_16x16x32_bf16 a[216:219], v[140:143], v[120:123], a[216:219]
    s_waitcnt vmcnt(9)
    s_buffer_load_dword s45, s[16:19], s71 offset:384
    v_mfma_f32_16x16x32_bf16 a[236:239], v[140:143], v[64:67], a[236:239]
    buffer_load_dwordx4 v[96:99], v62, s[16:19], s0 offen sc1
    v_mfma_f32_16x16x32_bf16 a[240:243], a[0:3], v[64:67], a[240:243]
    s_xor_b32 s0, s78, 29696
    v_mfma_f32_16x16x32_bf16 a[220:223], a[0:3], v[120:123], a[220:223]
    v_mfma_f32_16x16x32_bf16 a[200:203], a[0:3], v[112:115], a[200:203]
    v_mfma_f32_16x16x32_bf16 v[32:35], a[0:3], v[108:111], v[32:35]
    buffer_load_dwordx4 v[100:103], v62, s[16:19], s0 offen sc1
    v_mfma_f32_16x16x32_bf16 v[36:39], a[4:7], v[108:111], v[36:39]
    s_xor_b32 s0, s78, 30720
    v_mfma_f32_16x16x32_bf16 a[204:207], a[4:7], v[112:115], a[204:207]
    v_mfma_f32_16x16x32_bf16 a[224:227], a[4:7], v[120:123], a[224:227]
    v_mfma_f32_16x16x32_bf16 a[244:247], a[4:7], v[64:67], a[244:247]
    buffer_load_dwordx4 v[104:107], v62, s[16:19], s0 offen sc1
    v_mfma_f32_16x16x32_bf16 a[248:251], a[8:11], v[64:67], a[248:251]
    s_xor_b32 s0, s78, 31744
    v_mfma_f32_16x16x32_bf16 a[228:231], a[8:11], v[120:123], a[228:231]
    v_mfma_f32_16x16x32_bf16 a[208:211], a[8:11], v[112:115], a[208:211]
    v_mfma_f32_16x16x32_bf16 v[40:43], a[8:11], v[108:111], v[40:43]
    buffer_load_dwordx4 a[0:3], v62, s[16:19], s0 offen sc1
    v_mfma_f32_16x16x32_bf16 v[44:47], a[12:15], v[108:111], v[44:47]
    v_mfma_f32_16x16x32_bf16 a[212:215], a[12:15], v[112:115], a[212:215]
    v_mfma_f32_16x16x32_bf16 a[232:235], a[12:15], v[120:123], a[232:235]
    v_mfma_f32_16x16x32_bf16 a[252:255], a[12:15], v[64:67], a[252:255]
    s_waitcnt vmcnt(11)
    buffer_load_dwordx4 a[4:7], v62, s[16:19], s7 offen offset:3072 sc1
    v_mfma_f32_16x16x32_bf16 v[28:31], a[16:19], v[68:71], v[28:31]
    s_waitcnt vmcnt(11)
    v_mfma_f32_16x16x32_bf16 a[196:199], a[16:19], v[72:75], a[196:199]
    s_waitcnt vmcnt(10)
    v_mfma_f32_16x16x32_bf16 a[216:219], a[16:19], v[76:79], a[216:219]
    s_waitcnt vmcnt(9)
    v_mfma_f32_16x16x32_bf16 a[236:239], a[16:19], v[80:83], a[236:239]
    buffer_load_dwordx4 v[192:195], v119, s[16:19], s7 offen offset:0 sc1
    v_mfma_f32_16x16x32_bf16 a[240:243], a[20:23], v[80:83], a[240:243]
    v_mfma_f32_16x16x32_bf16 a[220:223], a[20:23], v[76:79], a[220:223]
    v_mfma_f32_16x16x32_bf16 a[200:203], a[20:23], v[72:75], a[200:203]
    v_mfma_f32_16x16x32_bf16 v[32:35], a[20:23], v[68:71], v[32:35]
    buffer_load_dwordx4 v[196:199], v62, s[16:19], s59 offen offset:0 sc1
    v_mfma_f32_16x16x32_bf16 v[36:39], a[24:27], v[68:71], v[36:39]
    v_mfma_f32_16x16x32_bf16 a[204:207], a[24:27], v[72:75], a[204:207]
    v_mfma_f32_16x16x32_bf16 a[224:227], a[24:27], v[76:79], a[224:227]
    s_waitcnt lgkmcnt(0)
    s_and_b64 s[42:43], s[42:43], s[44:45]
    s_and_b32 s42, s42, s43
    v_mfma_f32_16x16x32_bf16 a[244:247], a[24:27], v[80:83], a[244:247]
    s_andn2_b64 vcc, 0x101, s[42:43]
    s_cbranch_vccnz K_slow4
K_back4:
    v_mfma_f32_16x16x32_bf16 a[248:251], a[28:31], v[80:83], a[248:251]
    buffer_load_dwordx4 v[200:203], v62, s[16:19], s59 offen offset:1024 sc1
    v_mfma_f32_16x16x32_bf16 a[228:231], a[28:31], v[76:79], a[228:231]
    s_xor_b32 s0, s77, 1024
    v_mfma_f32_16x16x32_bf16 a[208:211], a[28:31], v[72:75], a[208:211]
    v_mfma_f32_16x16x32_bf16 v[40:43], a[28:31], v[68:71], v[40:43]
    v_mfma_f32_16x16x32_bf16 v[44:47], a[32:35], v[68:71], v[44:47]
    buffer_load_dwordx4 v[108:111], v62, s[16:19], s0 offen sc1
    v_mfma_f32_16x16x32_bf16 a[212:215], a[32:35], v[72:75], a[212:215]
    s_xor_b32 s0, s77, 2048
    v_mfma_f32_16x16x32_bf16 a[232:235], a[32:35], v[76:79], a[232:235]
    v_mfma_f32_16x16x32_bf16 a[252:255], a[32:35], v[80:83], a[252:255]
    s_waitcnt vmcnt(12)
    v_mfma_f32_16x16x32_bf16 v[28:31], a[36:39], v[84:87], v[28:31]
    s_waitcnt vmcnt(11)
    buffer_load_dwordx4 v[112:115], v62, s[16:19], s0 offen sc1
    v_mfma_f32_16x16x32_bf16 a[196:199], a[36:39], v[88:91], a[196:199]
    s_waitcnt vmcnt(11)
    s_xor_b32 s0, s77, 3072
    v_mfma_f32_16x16x32_bf16 a[216:219], a[36:39], v[92:95], a[216:219]
    s_waitcnt vmcnt(10)
    v_mfma_f32_16x16x32_bf16 a[236:239], a[36:39], v[128:131], a[236:239]
    v_mfma_f32_16x16x32_bf16 a[240:243], a[44:47], v[128:131], a[240:243]
    buffer_load_dwordx4 v[120:123], v62, s[16:19], s0 offen sc1
    v_mfma_f32_16x16x32_bf16 a[220:223], a[44:47], v[92:95], a[220:223]
    s_xor_b32 s0, s77, 5120
    v_mfma_f32_16x16x32_bf16 a[200:203], a[44:47], v[88:91], a[200:203]
    buffer_load_dwordx4 v[64:67], v62, s[16:19], s0 offen sc1
    v_mfma_f32_16x16x32_bf16 v[32:35], a[44:47], v[84:87], v[32:35]
    s_xor_b32 s0, s77, 6144
    v_mfma_f32_16x16x32_bf16 v[36:39], a[56:59], v[84:87], v[36:39]
    v_mfma_f32_16x16x32_bf16 a[204:207], a[56:59], v[88:91], a[204:207]
    v_mfma_f32_16x16x32_bf16 a[224:227], a[56:59], v[92:95], a[224:227]
    buffer_load_dwordx4 v[68:71], v62, s[16:19], s0 offen sc1
    v_mfma_f32_16x16x32_bf16 a[244:247], a[56:59], v[128:131], a[244:247]
    s_xor_b32 s0, s77, 7168
    v_mfma_f32_16x16x32_bf16 a[248:251], v[144:147], v[128:131], a[248:251]
    v_mfma_f32_16x16x32_bf16 a[228:231], v[144:147], v[92:95], a[228:231]
    v_mfma_f32_16x16x32_bf16 a[208:211], v[144:147], v[88:91], a[208:211]
    buffer_load_dwordx4 v[72:75], v62, s[16:19], s0 offen sc1
    v_mfma_f32_16x16x32_bf16 v[40:43], v[144:147], v[84:87], v[40:43]
    s_xor_b32 s0, s77, 9216
    v_mfma_f32_16x16x32_bf16 v[44:47], v[240:243], v[84:87], v[44:47]
    v_mfma_f32_16x16x32_bf16 a[212:215], v[240:243], v[88:91], a[212:215]
    v_mfma_f32_16x16x32_bf16 a[232:235], v[240:243], v[92:95], a[232:235]
    buffer_load_dwordx4 v[76:79], v62, s[16:19], s0 offen sc1
    v_mfma_f32_16x16x32_bf16 a[252:255], v[240:243], v[128:131], a[252:255]
    s_waitcnt vmcnt(14)
    s_xor_b32 s0, s77, 10240
    v_mfma_f32_16x16x32_bf16 v[28:31], v[244:247], v[96:99], v[28:31]
    s_waitcnt vmcnt(13)
    v_mfma_f32_16x16x32_bf16 a[196:199], v[244:247], v[100:103], a[196:199]
    s_waitcnt vmcnt(12)
    v_mfma_f32_16x16x32_bf16 a[216:219], v[244:247], v[104:107], a[216:219]
    s_waitcnt vmcnt(11)
    buffer_load_dwordx4 v[80:83], v62, s[16:19], s0 offen sc1
    v_mfma_f32_16x16x32_bf16 a[236:239], v[244:247], a[0:3], a[236:239]
    s_xor_b32 s0, s77, 11264
    v_mfma_f32_16x16x32_bf16 a[240:243], v[248:251], a[0:3], a[240:243]
    v_mfma_f32_16x16x32_bf16 a[220:223], v[248:251], v[104:107], a[220:223]
    v_mfma_f32_16x16x32_bf16 a[200:203], v[248:251], v[100:103], a[200:203]
    buffer_load_dwordx4 v[84:87], v62, s[16:19], s0 offen sc1
    v_mfma_f32_16x16x32_bf16 v[32:35], v[248:251], v[96:99], v[32:35]
    s_xor_b32 s0, s77, 13312
    v_mfma_f32_16x16x32_bf16 v[36:39], v[252:255], v[96:99], v[36:39]
    v_mfma_f32_16x16x32_bf16 a[204:207], v[252:255], v[100:103], a[204:207]
    v_mfma_f32_16x16x32_bf16 a[224:227], v[252:255], v[104:107], a[224:227]
    buffer_load_dwordx4 v[88:91], v62, s[16:19], s0 offen sc1
    v_mfma_f32_16x16x32_bf16 a[244:247], v[252:255], a[0:3], a[244:247]
    s_xor_b32 s0, s77, 14336
    v_mfma_f32_16x16x32_bf16 a[248:251], a[192:195], a[0:3], a[248:251]
    v_mfma_f32_16x16x32_bf16 a[228:231], a[192:195], v[104:107], a[228:231]
    v_mfma_f32_16x16x32_bf16 a[208:211], a[192:195], v[100:103], a[208:211]
    buffer_load_dwordx4 v[92:95], v62, s[16:19], s0 offen sc1
    v_mfma_f32_16x16x32_bf16 v[40:43], a[192:195], v[96:99], v[40:43]
    s_xor_b32 s0, s77, 15360
    v_mfma_f32_16x16x32_bf16 v[44:47], a[60:63], v[96:99], v[44:47]
    v_mfma_f32_16x16x32_bf16 a[212:215], a[60:63], v[100:103], a[212:215]
    v_mfma_f32_16x16x32_bf16 a[232:235], a[60:63], v[104:107], a[232:235]
    buffer_load_dwordx4 v[96:99], v62, s[16:19], s0 offen sc1
    v_mfma_f32_16x16x32_bf16 a[252:255], a[60:63], a[0:3], a[252:255]
    s_waitcnt vmcnt(11)
    s_xor_b32 s0, s77, 0
    v_mfma_f32_16x16x32_bf16 a[196:199], a[64:67], v[108:111], a[196:199]
    s_waitcnt vmcnt(10)
    buffer_load_dwordx4 a[8:11], v62, s[16:19], s0 offen sc1
    v_mfma_f32_16x16x32_bf16 a[216:219], a[64:67], v[112:115], a[216:219]
    s_waitcnt vmcnt(10)
    s_xor_b32 s0, s77, 4096
    v_mfma_f32_16x16x32_bf16 a[236:239], a[64:67], v[120:123], a[236:239]
    v_mfma_f32_16x16x32_bf16 a[240:243], a[68:71], v[120:123], a[240:243]
    v_mfma_f32_16x16x32_bf16 a[220:223], a[68:71], v[112:115], a[220:223]
    s_buffer_load_dword s24, s[16:19], s72 offset:0
    s_buffer_load_dword s25, s[16:19], s72 offset:128
    v_mfma_f32_16x16x32_bf16 a[200:203], a[68:71], v[108:111], a[200:203]
    s_buffer_load_dword s26, s[16:19], s72 offset:256
    s_buffer_load_dword s27, s[16:19], s72 offset:384
    v_mfma_f32_16x16x32_bf16 a[204:207], a[72:75], v[108:111], a[204:207]
    s_buffer_load_dword s28, s[16:19], s72 offset:512
    s_buffer_load_dword s29, s[16:19], s72 offset:640
    v_mfma_f32_16x16x32_bf16 a[224:227], a[72:75], v[112:115], a[224:227]
    s_buffer_load_dword s30, s[16:19], s72 offset:768
    s_buffer_load_dword s31, s[16:19], s72 offset:896
    v_mfma_f32_16x16x32_bf16 a[244:247], a[72:75], v[120:123], a[244:247]
    buffer_load_dwordx4 a[0:3], v62, s[16:19], s0 offen sc1
    v_mfma_f32_16x16x32_bf16 a[248:251], a[76:79], v[120:123], a[248:251]
    s_xor_b32 s0, s77, 8192
    v_mfma_f32_16x16x32_bf16 a[228:231], a[76:79], v[112:115], a[228:231]
    v_mfma_f32_16x16x32_bf16 a[208:211], a[76:79], v[108:111], a[208:211]
    v_mfma_f32_16x16x32_bf16 a[212:215], a[80:83], v[108:111], a[212:215]
    buffer_load_dwordx4 a[12:15], v62, s[16:19], s0 offen sc1
    v_mfma_f32_16x16x32_bf16 a[232:235], a[80:83], v[112:115], a[232:235]
    s_xor_b32 s0, s77, 12288
    v_mfma_f32_16x16x32_bf16 a[252:255], a[80:83], v[120:123], a[252:255]
    s_waitcnt vmcnt(11)
    v_mfma_f32_16x16x32_bf16 a[196:199], a[84:87], v[64:67], a[196:199]
    s_waitcnt vmcnt(10)
    v_mfma_f32_16x16x32_bf16 a[216:219], a[84:87], v[68:71], a[216:219]
    s_waitcnt vmcnt(9)
    buffer_load_dwordx4 v[208:211], v62, s[16:19], s0 offen sc1
    v_mfma_f32_16x16x32_bf16 a[236:239], a[84:87], v[72:75], a[236:239]
    v_mfma_f32_16x16x32_bf16 a[240:243], a[88:91], v[72:75], a[240:243]
    v_mfma_f32_16x16x32_bf16 a[220:223], a[88:91], v[68:71], a[220:223]
    v_mfma_f32_16x16x32_bf16 a[200:203], a[88:91], v[64:67], a[200:203]
    buffer_load_dwordx4 v[212:215], v62, s[16:19], s59 offen offset:2048 sc1
    v_mfma_f32_16x16x32_bf16 a[204:207], a[92:95], v[64:67], a[204:207]
    v_mfma_f32_16x16x32_bf16 a[224:227], a[92:95], v[68:71], a[224:227]
    v_mfma_f32_16x16x32_bf16 a[244:247], a[92:95], v[72:75], a[244:247]
    v_mfma_f32_16x16x32_bf16 a[248:251], a[96:99], v[72:75], a[248:251]
    buffer_load_dwordx4 v[216:219], v62, s[16:19], s59 offen offset:3072 sc1
    v_mfma_f32_16x16x32_bf16 a[228:231], a[96:99], v[68:71], a[228:231]
    v_mfma_f32_16x16x32_bf16 a[208:211], a[96:99], v[64:67], a[208:211]
    v_mfma_f32_16x16x32_bf16 a[212:215], a[100:103], v[64:67], a[212:215]
    v_mfma_f32_16x16x32_bf16 a[232:235], a[100:103], v[68:71], a[232:235]
    buffer_load_dwordx4 v[220:223], v0, s[16:19], s59 offen offset:0 sc1
    v_mfma_f32_16x16x32_bf16 a[252:255], a[100:103], v[72:75], a[252:255]
    s_waitcnt vmcnt(12)
    v_mfma_f32_16x16x32_bf16 a[196:199], a[104:107], v[76:79], a[196:199]
    s_waitcnt vmcnt(11)
    v_mfma_f32_16x16x32_bf16 a[216:219], a[104:107], v[80:83], a[216:219]
    s_waitcnt vmcnt(10)
    v_mfma_f32_16x16x32_bf16 a[236:239], a[104:107], v[84:87], a[236:239]
    s_waitcnt vmcnt(9)
    buffer_load_dwordx4 v[224:227], v62, s[16:19], s60 offen offset:0 sc1
    v_mfma_f32_16x16x32_bf16 a[196:199], a[52:55], v[88:91], a[196:199]
    s_waitcnt vmcnt(9)
    v_mfma_f32_16x16x32_bf16 a[216:219], a[52:55], v[92:95], a[216:219]
    s_waitcnt vmcnt(8) lgkmcnt(0)
    s_and_b64 s[24:25], s[24:25], s[26:27]
    s_and_b64 s[24:25], s[24:25], s[28:29]
    v_mfma_f32_16x16x32_bf16 a[236:239], a[52:55], v[96:99], a[236:239]
    s_and_b64 s[24:25], s[24:25], s[30:31]
    s_and_b32 s24, s24, s25
    v_mfma_f32_16x16x32_bf16 a[200:203], a[108:111], v[76:79], a[200:203]
    s_andn2_b64 vcc, 0x1010101, s[24:25]
    s_cbranch_vccnz K_slow5
K_back5:
    v_mfma_f32_16x16x32_bf16 a[220:223], a[108:111], v[80:83], a[220:223]
    ds_write_b128 v7, a[196:199] offset:0
    v_mfma_f32_16x16x32_bf16 a[240:243], a[108:111], v[84:87], a[240:243]
    buffer_load_dwordx4 v[228:231], v62, s[16:19], s60 offen offset:1024 sc1
    v_mfma_f32_16x16x32_bf16 a[200:203], a[48:51], v[88:91], a[200:203]
    ds_write_b128 v63, a[216:219] offset:20480
    v_mfma_f32_16x16x32_bf16 a[220:223], a[48:51], v[92:95], a[220:223]
    v_mfma_f32_16x16x32_bf16 a[240:243], a[48:51], v[96:99], a[240:243]
    ds_write_b128 v3, a[236:239] offset:40960
    v_mfma_f32_16x16x32_bf16 a[204:207], a[112:115], v[76:79], a[204:207]
    buffer_load_dwordx4 v[232:235], v7, s[16:19], s34 offen sc1
    v_mfma_f32_16x16x32_bf16 a[224:227], a[112:115], v[80:83], a[224:227]
    v_mfma_f32_16x16x32_bf16 a[244:247], a[112:115], v[84:87], a[244:247]
    ds_write_b128 v7, a[200:203] offset:4096
    v_mfma_f32_16x16x32_bf16 a[204:207], v[204:207], v[88:91], a[204:207]
    v_mfma_f32_16x16x32_bf16 a[224:227], v[204:207], v[92:95], a[224:227]
    ds_write_b128 v63, a[220:223] offset:24576
    v_mfma_f32_16x16x32_bf16 a[244:247], v[204:207], v[96:99], a[244:247]
    buffer_load_dwordx4 v[236:239], v63, s[16:19], s34 offen sc1
    v_mfma_f32_16x16x32_bf16 a[208:211], a[116:119], v[76:79], a[208:211]
    ds_write_b128 v3, a[240:243] offset:45056
    v_mfma_f32_16x16x32_bf16 a[228:231], a[116:119], v[80:83], a[228:231]
    v_mfma_f32_16x16x32_bf16 a[248:251], a[116:119], v[84:87], a[248:251]
    ds_write_b128 v7, a[204:207] offset:8192
    v_mfma_f32_16x16x32_bf16 a[208:211], a[4:7], v[88:91], a[208:211]
    buffer_load_dwordx4 v[240:243], v3, s[16:19], s34 offen sc1
    v_mfma_f32_16x16x32_bf16 a[228:231], a[4:7], v[92:95], a[228:231]
    ds_write_b128 v63, a[224:227] offset:28672
    v_mfma_f32_16x16x32_bf16 a[248:251], a[4:7], v[96:99], a[248:251]
    v_mfma_f32_16x16x32_bf16 a[212:215], a[40:43], v[76:79], a[212:215]
    ds_write_b128 v3, a[244:247] offset:49152
    v_mfma_f32_16x16x32_bf16 a[232:235], a[40:43], v[80:83], a[232:235]
    buffer_load_dwordx4 v[244:247], v7, s[16:19], s35 offen sc1
    v_mfma_f32_16x16x32_bf16 a[252:255], a[40:43], v[84:87], a[252:255]
    ds_write_b128 v7, a[208:211] offset:12288
    v_mfma_f32_16x16x32_bf16 a[212:215], v[192:195], v[88:91], a[212:215]
    v_mfma_f32_16x16x32_bf16 a[232:235], v[192:195], v[92:95], a[232:235]
    ds_write_b128 v63, a[228:231] offset:32768
    v_mfma_f32_16x16x32_bf16 a[252:255], v[192:195], v[96:99], a[252:255]
    s_waitcnt vmcnt(12)
    buffer_load_dwordx4 v[248:251], v63, s[16:19], s35 offen sc1
    v_mfma_f32_16x16x32_bf16 v[28:31], a[64:67], a[8:11], v[28:31]
    s_waitcnt vmcnt(12)
    ds_write_b128 v3, a[248:251] offset:53248
    v_mfma_f32_16x16x32_bf16 v[28:31], a[84:87], a[0:3], v[28:31]
    s_waitcnt vmcnt(11)
    v_mfma_f32_16x16x32_bf16 v[28:31], a[104:107], a[12:15], v[28:31]
    s_waitcnt vmcnt(10)
    ds_write_b128 v7, a[212:215] offset:16384
    v_mfma_f32_16x16x32_bf16 v[28:31], a[52:55], v[208:211], v[28:31]
    buffer_load_dwordx4 v[252:255], v3, s[16:19], s35 offen sc1
    v_mfma_f32_16x16x32_bf16 v[32:35], a[68:71], a[8:11], v[32:35]
    ds_write_b128 v63, a[232:235] offset:36864
    v_mfma_f32_16x16x32_bf16 v[32:35], a[88:91], a[0:3], v[32:35]
    v_mfma_f32_16x16x32_bf16 v[32:35], a[108:111], a[12:15], v[32:35]
    ds_write_b128 v3, a[252:255] offset:57344
    v_mfma_f32_16x16x32_bf16 v[32:35], a[48:51], v[208:211], v[32:35]
    buffer_load_dwordx4 a[192:195], v62, s[16:19], s60 offen offset:2048 sc1
    v_mfma_f32_16x16x32_bf16 v[36:39], a[72:75], a[8:11], v[36:39]
    v_mfma_f32_16x16x32_bf16 v[36:39], a[92:95], a[0:3], v[36:39]
    s_waitcnt lgkmcnt(0)
    v_mfma_f32_16x16x32_bf16 v[36:39], a[112:115], a[12:15], v[36:39]
    s_barrier
    ds_read_b128 v[64:67], v6 offset:0
    ds_read_b128 v[68:71], v6 offset:20480
    ds_read_b128 v[72:75], v6 offset:40960
    v_mfma_f32_16x16x32_bf16 v[36:39], v[204:207], v[208:211], v[36:39]
    buffer_load_dwordx4 a[60:63], v62, s[16:19], s60 offen offset:3072 sc1
    v_mfma_f32_16x16x32_bf16 v[40:43], a[76:79], a[8:11], v[40:43]
    ds_read_b128 v[76:79], v6 offset:4096
    ds_read_b128 v[80:83], v6 offset:24576
    ds_read_b128 v[84:87], v6 offset:45056
    v_mfma_f32_16x16x32_bf16 v[40:43], a[96:99], a[0:3], v[40:43]
    v_mfma_f32_16x16x32_bf16 v[40:43], a[116:119], a[12:15], v[40:43]
    ds_read_b128 v[88:91], v6 offset:8192
    ds_read_b128 v[92:95], v6 offset:28672
    ds_read_b128 v[96:99], v6 offset:49152
    v_mfma_f32_16x16x32_bf16 v[40:43], a[4:7], v[208:211], v[40:43]
    s_waitcnt lgkmcnt(7)
    buffer_load_dwordx4 v[204:207], v0, s[16:19], s60 offen offset:0 sc1
    v_add_f32 v64, v64, v68
    v_add_f32 v65, v65, v69
    v_mfma_f32_16x16x32_bf16 v[44:47], a[80:83], a[8:11], v[44:47]
    ds_read_b128 v[100:103], v6 offset:12288
    ds_read_b128 v[104:107], v6 offset:32768
    ds_read_b128 v[108:111], v6 offset:53248
    v_add_f32 v66, v66, v70
    v_mfma_f32_16x16x32_bf16 v[44:47], a[100:103], a[0:3], v[44:47]
    s_waitcnt lgkmcnt(9)
    v_add_f32 v67, v67, v71
    v_add_f32 v28, v28, v72
    v_add_f32 v29, v29, v73
    v_add_f32 v30, v30, v74
    v_mfma_f32_16x16x32_bf16 v[44:47], a[40:43], a[12:15], v[44:47]
    ds_read_b128 v[112:115], v6 offset:16384
    ds_read_b128 v[116:119], v6 offset:36864
    ds_read_b128 v[120:123], v6 offset:57344
    v_add_f32 v31, v31, v75
    v_mfma_f32_16x16x32_bf16 v[44:47], v[192:195], v[208:211], v[44:47]
    s_waitcnt vmcnt(8)
    buffer_load_dwordx4 a[64:67], v62, s[16:19], s61 offen offset:0 sc1
    v_add_f32 v28, v28, v64
    v_add_f32 v29, v29, v65
    v_mfma_f32_16x16x32_bf16 a[0:3], v[196:199], v[232:235], 0
    s_waitcnt vmcnt(8)
    v_exp_f32_e64 v48, -v28
    v_exp_f32_e64 v49, -v29
    v_mfma_f32_16x16x32_bf16 a[20:23], v[196:199], v[236:239], 0
    s_waitcnt vmcnt(7)
    v_add_f32 v30, v30, v66
    v_exp_f32_e64 v50, -v30
    v_add_f32 v31, v31, v67
    v_mfma_f32_16x16x32_bf16 a[40:43], v[196:199], v[240:243], 0
    v_exp_f32_e64 v51, -v31
    v_fma_f32 v48, v48, s58, s58
    v_fma_f32 v49, v49, s58, s58
    v_mfma_f32_16x16x32_bf16 a[44:47], v[200:203], v[240:243], 0
    buffer_load_dwordx4 v[192:195], v7, s[16:19], s36 offen sc1
    v_rcp_f32 v48, v48
    v_mfma_f32_16x16x32_bf16 a[24:27], v[200:203], v[236:239], 0
    v_rcp_f32 v49, v49
    v_fma_f32 v50, v50, s58, s58
    v_fma_f32 v51, v51, s58, s58
    v_mfma_f32_16x16x32_bf16 a[4:7], v[200:203], v[232:235], 0
    buffer_load_dwordx4 v[208:211], v63, s[16:19], s36 offen sc1
    v_rcp_f32 v50, v50
    v_mfma_f32_16x16x32_bf16 a[8:11], v[212:215], v[232:235], 0
    v_rcp_f32 v51, v51
    v_mul_f32 v28, v28, v48
    v_mul_f32 v29, v29, v49
    v_mfma_f32_16x16x32_bf16 a[28:31], v[212:215], v[236:239], 0
    buffer_load_dwordx4 a[68:71], v3, s[16:19], s36 offen sc1
    v_mul_f32 v30, v30, v50
    v_mul_f32 v31, v31, v51
    v_mfma_f32_16x16x32_bf16 a[48:51], v[212:215], v[240:243], 0
    s_waitcnt lgkmcnt(10)
    v_add_f32 v76, v76, v80
    v_add_f32 v77, v77, v81
    v_add_f32 v78, v78, v82
    v_add_f32 v79, v79, v83
    v_mfma_f32_16x16x32_bf16 a[52:55], v[216:219], v[240:243], 0
    s_waitcnt lgkmcnt(9)
    buffer_load_dwordx4 a[72:75], v62, s[16:19], s61 offen offset:1024 sc1
    v_add_f32 v32, v32, v84
    v_add_f32 v33, v33, v85
    v_mfma_f32_16x16x32_bf16 a[32:35], v[216:219], v[236:239], 0
    v_add_f32 v34, v34, v86
    v_add_f32 v35, v35, v87
    v_add_f32 v32, v32, v76
    v_add_f32 v33, v33, v77
    v_mfma_f32_16x16x32_bf16 a[12:15], v[216:219], v[232:235], 0
    buffer_load_dwordx4 a[76:79], v62, s[16:19], s61 offen offset:2048 sc1
    v_exp_f32_e64 v52, -v32
    v_mfma_f32_16x16x32_bf16 a[16:19], v[220:223], v[232:235], 0
    v_exp_f32_e64 v53, -v33
    v_add_f32 v34, v34, v78
    v_add_f32 v35, v35, v79
    v_mfma_f32_16x16x32_bf16 a[36:39], v[220:223], v[236:239], 0
    buffer_load_dwordx4 a[80:83], v62, s[16:19], s61 offen offset:3072 sc1
    v_exp_f32_e64 v54, -v34
    v_mfma_f32_16x16x32_bf16 a[56:59], v[220:223], v[240:243], 0
    s_waitcnt vmcnt(12)
    v_exp_f32_e64 v55, -v35
    v_fma_f32 v52, v52, s58, s58
    v_fma_f32 v53, v53, s58, s58
    v_mfma_f32_16x16x32_bf16 a[0:3], v[224:227], v[244:247], a[0:3]
    s_waitcnt vmcnt(11)
    buffer_load_dwordx4 v[232:235], v0, s[16:19], s61 offen offset:0 sc1
    v_rcp_f32 v52, v52
    v_mfma_f32_16x16x32_bf16 a[20:23], v[224:227], v[248:251], a[20:23]
    s_waitcnt vmcnt(11)
    v_rcp_f32 v53, v53
    v_fma_f32 v54, v54, s58, s58
    v_fma_f32 v55, v55, s58, s58
    v_mfma_f32_16x16x32_bf16 a[40:43], v[224:227], v[252:255], a[40:43]
    buffer_load_dwordx4 v[236:239], v62, s[16:19], s62 offen offset:0 sc1
    v_rcp_f32 v54, v54
    v_mfma_f32_16x16x32_bf16 a[44:47], v[228:231], v[252:255], a[44:47]
    v_rcp_f32 v55, v55
    v_mul_f32 v32, v32, v52
    v_mul_f32 v33, v33, v53
    v_mfma_f32_16x16x32_bf16 a[24:27], v[228:231], v[248:251], a[24:27]
    buffer_load_dwordx4 v[240:243], v7, s[16:19], s37 offen sc1
    v_mul_f32 v34, v34, v54
    v_mul_f32 v35, v35, v55
    v_mfma_f32_16x16x32_bf16 a[4:7], v[228:231], v[244:247], a[4:7]
    s_waitcnt lgkmcnt(7)
    v_add_f32 v88, v88, v92
    v_add_f32 v89, v89, v93
    v_add_f32 v90, v90, v94
    v_add_f32 v91, v91, v95
    s_waitcnt vmcnt(12)
    v_mfma_f32_16x16x32_bf16 a[8:11], a[192:195], v[244:247], a[8:11]
    s_waitcnt lgkmcnt(6)
    buffer_load_dwordx4 a[84:87], v63, s[16:19], s37 offen sc1
    v_add_f32 v36, v36, v96
    v_add_f32 v37, v37, v97
    v_mfma_f32_16x16x32_bf16 a[28:31], a[192:195], v[248:251], a[28:31]
    v_add_f32 v38, v38, v98
    v_add_f32 v39, v39, v99
    v_add_f32 v36, v36, v88
    v_add_f32 v37, v37, v89
    v_mfma_f32_16x16x32_bf16 a[48:51], a[192:195], v[252:255], a[48:51]
    s_waitcnt vmcnt(12)
    buffer_load_dwordx4 a[88:91], v3, s[16:19], s37 offen sc1
    v_exp_f32_e64 v48, -v36
    v_mfma_f32_16x16x32_bf16 a[52:55], a[60:63], v[252:255], a[52:55]
    v_exp_f32_e64 v49, -v37
    v_add_f32 v38, v38, v90
    v_add_f32 v39, v39, v91
    v_mfma_f32_16x16x32_bf16 a[32:35], a[60:63], v[248:251], a[32:35]
    buffer_load_dwordx4 a[92:95], v62, s[16:19], s63 offen offset:0 sc1
    v_exp_f32_e64 v50, -v38
    v_mfma_f32_16x16x32_bf16 a[12:15], a[60:63], v[244:247], a[12:15]
    s_waitcnt vmcnt(13)
    v_exp_f32_e64 v51, -v39
    v_fma_f32 v48, v48, s58, s58
    v_fma_f32 v49, v49, s58, s58
    v_mfma_f32_16x16x32_bf16 a[16:19], v[204:207], v[244:247], a[16:19]
    buffer_load_dwordx4 a[96:99], v7, s[16:19], s38 offen sc1
    v_rcp_f32 v48, v48
    v_mfma_f32_16x16x32_bf16 a[36:39], v[204:207], v[248:251], a[36:39]
    v_rcp_f32 v49, v49
    v_fma_f32 v50, v50, s58, s58
    v_fma_f32 v51, v51, s58, s58
    v_mfma_f32_16x16x32_bf16 a[56:59], v[204:207], v[252:255], a[56:59]
    s_waitcnt vmcnt(12)
    buffer_load_dwordx4 v[244:247], v63, s[16:19], s38 offen sc1
    v_rcp_f32 v50, v50
    v_mfma_f32_16x16x32_bf16 a[0:3], a[64:67], v[192:195], a[0:3]
    s_waitcnt vmcnt(12)
    v_rcp_f32 v51, v51
    v_mul_f32 v36, v36, v48
    v_mul_f32 v37, v37, v49
    v_mfma_f32_16x16x32_bf16 a[20:23], a[64:67], v[208:211], a[20:23]
    s_waitcnt vmcnt(11)
    buffer_load_dwordx4 v[248:251], v3, s[16:19], s38 offen sc1
    v_mul_f32 v38, v38, v50
    v_mul_f32 v39, v39, v51
    v_mfma_f32_16x16x32_bf16 a[40:43], a[64:67], a[68:71], a[40:43]
    s_waitcnt lgkmcnt(4)
    v_add_f32 v100, v100, v104
    v_add_f32 v101, v101, v105
    v_add_f32 v102, v102, v106
    v_add_f32 v103, v103, v107
    s_waitcnt vmcnt(11)
    v_mfma_f32_16x16x32_bf16 a[44:47], a[72:75], a[68:71], a[44:47]
    s_waitcnt lgkmcnt(3)
    buffer_load_dwordx4 v[252:255], v62, s[16:19], s62 offen offset:1024 sc1
    v_add_f32 v40, v40, v108
    v_add_f32 v41, v41, v109
    v_mfma_f32_16x16x32_bf16 a[24:27], a[72:75], v[208:211], a[24:27]
    v_add_f32 v42, v42, v110
    v_add_f32 v43, v43, v111
    v_add_f32 v40, v40, v100
    v_add_f32 v41, v41, v101
    v_mfma_f32_16x16x32_bf16 a[4:7], a[72:75], v[192:195], a[4:7]
    s_waitcnt vmcnt(11)
    buffer_load_dwordx4 a[100:103], v62, s[16:19], s63 offen offset:1024 sc1
    v_exp_f32_e64 v52, -v40
    v_mfma_f32_16x16x32_bf16 a[8:11], a[76:79], v[192:195], a[8:11]
    v_exp_f32_e64 v53, -v41
    v_add_f32 v42, v42, v102
    v_add_f32 v43, v43, v103
    v_mfma_f32_16x16x32_bf16 a[28:31], a[76:79], v[208:211], a[28:31]
    buffer_load_dwordx4 a[104:107], v62, s[16:19], s62 offen offset:2048 sc1
    v_exp_f32_e64 v54, -v42
    v_mfma_f32_16x16x32_bf16 a[48:51], a[76:79], a[68:71], a[48:51]
    s_waitcnt vmcnt(12)
    v_exp_f32_e64 v55, -v43
    v_fma_f32 v52, v52, s58, s58
    v_fma_f32 v53, v53, s58, s58
    v_mfma_f32_16x16x32_bf16 a[52:55], a[80:83], a[68:71], a[52:55]
    buffer_load_dwordx4 a[108:111], v62, s[16:19], s63 offen offset:2048 sc1
    v_rcp_f32 v52, v52
    v_mfma_f32_16x16x32_bf16 a[32:35], a[80:83], v[208:211], a[32:35]
    v_rcp_f32 v53, v53
    v_fma_f32 v54, v54, s58, s58
    v_fma_f32 v55, v55, s58, s58
    v_mfma_f32_16x16x32_bf16 a[12:15], a[80:83], v[192:195], a[12:15]
    s_waitcnt vmcnt(12)
    buffer_load_dwordx4 a[112:115], v62, s[16:19], s62 offen offset:3072 sc1
    v_rcp_f32 v54, v54
    v_mfma_f32_16x16x32_bf16 a[16:19], v[232:235], v[192:195], a[16:19]
    v_rcp_f32 v55, v55
    v_mul_f32 v40, v40, v52
    v_mul_f32 v41, v41, v53
    v_mfma_f32_16x16x32_bf16 a[36:39], v[232:235], v[208:211], a[36:39]
    buffer_load_dwordx4 a[116:119], v62, s[16:19], s63 offen offset:3072 sc1
    v_mul_f32 v42, v42, v54
    v_mul_f32 v43, v43, v55
    v_mfma_f32_16x16x32_bf16 a[56:59], v[232:235], a[68:71], a[56:59]
    s_waitcnt lgkmcnt(1)
    v_add_f32 v112, v112, v116
    v_add_f32 v113, v113, v117
    v_add_f32 v114, v114, v118
    v_add_f32 v115, v115, v119
    s_waitcnt vmcnt(12)
    v_mfma_f32_16x16x32_bf16 a[0:3], v[236:239], v[240:243], a[0:3]
    s_waitcnt vmcnt(11) lgkmcnt(0)
    buffer_load_dwordx4 v[192:195], v0, s[16:19], s62 offen offset:0 sc1
    v_add_f32 v44, v44, v120
    v_add_f32 v45, v45, v121
    v_mfma_f32_16x16x32_bf16 a[20:23], v[236:239], a[84:87], a[20:23]
    s_waitcnt vmcnt(11)
    v_add_f32 v46, v46, v122
    v_add_f32 v47, v47, v123
    v_add_f32 v44, v44, v112
    v_add_f32 v45, v45, v113
    v_mfma_f32_16x16x32_bf16 a[40:43], v[236:239], a[88:91], a[40:43]
    s_waitcnt vmcnt(9)
    buffer_load_dwordx4 v[208:211], v0, s[16:19], s63 offen offset:0 sc1
    v_exp_f32_e64 v48, -v44
    v_mfma_f32_16x16x32_bf16 a[0:3], a[92:95], a[96:99], a[0:3]
    s_waitcnt vmcnt(9)
    v_exp_f32_e64 v49, -v45
    v_add_f32 v46, v46, v114
    v_add_f32 v47, v47, v115
    v_mfma_f32_16x16x32_bf16 a[20:23], a[92:95], v[244:247], a[20:23]
    s_waitcnt vmcnt(8)
    buffer_load_dwordx4 a[68:71], v6, s[16:19], s34 offen sc1
    v_exp_f32_e64 v50, -v46
    v_mfma_f32_16x16x32_bf16 a[40:43], a[92:95], v[248:251], a[40:43]
    s_waitcnt vmcnt(8)
    v_exp_f32_e64 v51, -v47
    v_fma_f32 v48, v48, s58, s58
    v_fma_f32 v49, v49, s58, s58
    v_mfma_f32_16x16x32_bf16 a[4:7], v[252:255], v[240:243], a[4:7]
    buffer_load_dwordx4 a[120:123], v6, s[16:19], s35 offen sc1
    v_rcp_f32 v48, v48
    v_mfma_f32_16x16x32_bf16 a[24:27], v[252:255], a[84:87], a[24:27]
    v_rcp_f32 v49, v49
    v_fma_f32 v50, v50, s58, s58
    v_fma_f32 v51, v51, s58, s58
    v_mfma_f32_16x16x32_bf16 a[44:47], v[252:255], a[88:91], a[44:47]
    s_waitcnt vmcnt(8)
    ds_write_b128 v59, a[0:3] offset:0
    v_mfma_f32_16x16x32_bf16 a[4:7], a[100:103], a[96:99], a[4:7]
    v_rcp_f32 v50, v50
    v_rcp_f32 v51, v51
    v_mfma_f32_16x16x32_bf16 a[24:27], a[100:103], v[244:247], a[24:27]
    ds_write_b128 v61, a[20:23] offset:20480
    v_mfma_f32_16x16x32_bf16 a[44:47], a[100:103], v[248:251], a[44:47]
    s_waitcnt vmcnt(7)
    buffer_load_dwordx4 a[124:127], v6, s[16:19], s36 offen sc1
    v_mul_f32 v44, v44, v48
    v_mul_f32 v45, v45, v49
    v_mfma_f32_16x16x32_bf16 a[8:11], a[104:107], v[240:243], a[8:11]
    ds_write_b128 v5, a[40:43] offset:40960
    v_mfma_f32_16x16x32_bf16 a[28:31], a[104:107], a[84:87], a[28:31]
    v_mul_f32 v46, v46, v50
    v_mul_f32 v47, v47, v51
    v_mfma_f32_16x16x32_bf16 a[48:51], a[104:107], a[88:91], a[48:51]
    s_waitcnt vmcnt(7)
    ds_write_b128 v59, a[4:7] offset:4096
    v_mfma_f32_16x16x32_bf16 a[8:11], a[108:111], a[96:99], a[8:11]
    buffer_load_dwordx4 a[128:131], v6, s[16:19], s37 offen sc1
    v_mfma_f32_16x16x32_bf16 a[28:31], a[108:111], v[244:247], a[28:31]
    ds_write_b128 v61, a[24:27] offset:24576
    v_mfma_f32_16x16x32_bf16 a[48:51], a[108:111], v[248:251], a[48:51]
    s_waitcnt vmcnt(7)
    v_mfma_f32_16x16x32_bf16 a[12:15], a[112:115], v[240:243], a[12:15]
    ds_write_b128 v5, a[44:47] offset:45056
    v_mfma_f32_16x16x32_bf16 a[32:35], a[112:115], a[84:87], a[32:35]
    v_mfma_f32_16x16x32_bf16 a[52:55], a[112:115], a[88:91], a[52:55]
    s_waitcnt vmcnt(6)
    ds_write_b128 v59, a[8:11] offset:8192
    v_mfma_f32_16x16x32_bf16 a[12:15], a[116:119], a[96:99], a[12:15]
    buffer_load_dwordx4 a[132:135], v6, s[16:19], s38 offen sc1
    v_mfma_f32_16x16x32_bf16 a[32:35], a[116:119], v[244:247], a[32:35]
    ds_write_b128 v61, a[28:31] offset:28672
    v_mfma_f32_16x16x32_bf16 a[52:55], a[116:119], v[248:251], a[52:55]
    s_waitcnt vmcnt(6)
    v_mfma_f32_16x16x32_bf16 a[16:19], v[192:195], v[240:243], a[16:19]
    ds_write_b128 v5, a[48:51] offset:49152
    v_mfma_f32_16x16x32_bf16 a[36:39], v[192:195], a[84:87], a[36:39]
    v_mfma_f32_16x16x32_bf16 a[56:59], v[192:195], a[88:91], a[56:59]
    s_waitcnt vmcnt(5)
    ds_write_b128 v59, a[12:15] offset:12288
    v_mfma_f32_16x16x32_bf16 a[16:19], v[208:211], a[96:99], a[16:19]
    v_mfma_f32_16x16x32_bf16 a[36:39], v[208:211], v[244:247], a[36:39]
    ds_write_b128 v61, a[32:35] offset:32768
    v_mfma_f32_16x16x32_bf16 a[56:59], v[208:211], v[248:251], a[56:59]
    s_waitcnt vmcnt(4)
    v_mfma_f32_16x16x32_bf16 v[128:131], v[196:199], a[68:71], 0
    ds_write_b128 v5, a[52:55] offset:53248
    v_mfma_f32_16x16x32_bf16 v[132:135], v[200:203], a[68:71], 0
    v_mfma_f32_16x16x32_bf16 v[136:139], v[212:215], a[68:71], 0
    ds_write_b128 v59, a[16:19] offset:16384
    v_mfma_f32_16x16x32_bf16 v[140:143], v[216:219], a[68:71], 0
    v_mfma_f32_16x16x32_bf16 v[144:147], v[220:223], a[68:71], 0
    s_waitcnt vmcnt(3)
    ds_write_b128 v61, a[36:39] offset:36864
    v_mfma_f32_16x16x32_bf16 v[128:131], v[224:227], a[120:123], v[128:131]
    v_mfma_f32_16x16x32_bf16 v[132:135], v[228:231], a[120:123], v[132:135]
    ds_write_b128 v5, a[56:59] offset:57344
    v_mfma_f32_16x16x32_bf16 v[136:139], a[192:195], a[120:123], v[136:139]
    v_mfma_f32_16x16x32_bf16 v[140:143], a[60:63], a[120:123], v[140:143]
    v_mfma_f32_16x16x32_bf16 v[144:147], v[204:207], a[120:123], v[144:147]
    s_waitcnt vmcnt(2) lgkmcnt(0)
    v_mfma_f32_16x16x32_bf16 v[128:131], a[64:67], a[124:127], v[128:131]
    s_barrier
    ds_read_b128 v[64:67], v58 offset:0
    ds_read_b128 v[68:71], v58 offset:20480
    ds_read_b128 v[72:75], v58 offset:40960
    v_mfma_f32_16x16x32_bf16 v[132:135], a[72:75], a[124:127], v[132:135]
    v_mfma_f32_16x16x32_bf16 v[136:139], a[76:79], a[124:127], v[136:139]
    ds_read_b128 v[76:79], v58 offset:4096
    ds_read_b128 v[80:83], v58 offset:24576
    ds_read_b128 v[84:87], v58 offset:45056
    v_mfma_f32_16x16x32_bf16 v[140:143], a[80:83], a[124:127], v[140:143]
    v_mfma_f32_16x16x32_bf16 v[144:147], v[232:235], a[124:127], v[144:147]
    s_waitcnt vmcnt(1)
    ds_read_b128 v[88:91], v58 offset:8192
    ds_read_b128 v[92:95], v58 offset:28672
    ds_read_b128 v[96:99], v58 offset:49152
    v_mfma_f32_16x16x32_bf16 v[128:131], v[236:239], a[128:131], v[128:131]
    s_waitcnt lgkmcnt(8)
    v_fmac_f32 v8, v64, v28
    v_fmac_f32 v9, v65, v29
    v_mfma_f32_16x16x32_bf16 v[132:135], v[252:255], a[128:131], v[132:135]
    ds_read_b128 v[100:103], v58 offset:12288
    ds_read_b128 v[104:107], v58 offset:32768
    ds_read_b128 v[108:111], v58 offset:53248
    v_mfma_f32_16x16x32_bf16 v[136:139], a[104:107], a[128:131], v[136:139]
    v_fmac_f32 v10, v66, v30
    v_fmac_f32 v11, v67, v31
    v_mfma_f32_16x16x32_bf16 v[140:143], a[112:115], a[128:131], v[140:143]
    ds_read_b128 v[112:115], v58 offset:16384
    ds_read_b128 v[116:119], v58 offset:36864
    ds_read_b128 v[120:123], v58 offset:57344
    v_mfma_f32_16x16x32_bf16 v[144:147], v[192:195], a[128:131], v[144:147]
    s_waitcnt vmcnt(0) lgkmcnt(13)
    v_fmac_f32 v8, v68, v28
    v_fmac_f32 v9, v69, v29
    v_mfma_f32_16x16x32_bf16 v[128:131], a[92:95], a[132:135], v[128:131]
    v_fmac_f32 v10, v70, v30
    v_fmac_f32 v11, v71, v31
    v_mfma_f32_16x16x32_bf16 v[132:135], a[100:103], a[132:135], v[132:135]
    s_waitcnt lgkmcnt(12)
    v_fmac_f32 v8, v72, v28
    v_fmac_f32 v9, v73, v29
    v_mfma_f32_16x16x32_bf16 v[136:139], a[108:111], a[132:135], v[136:139]
    v_fmac_f32 v10, v74, v30
    v_fmac_f32 v11, v75, v31
    v_mfma_f32_16x16x32_bf16 v[140:143], a[116:119], a[132:135], v[140:143]
    s_waitcnt lgkmcnt(11)
    v_fmac_f32 v12, v76, v32
    v_fmac_f32 v13, v77, v33
    v_mfma_f32_16x16x32_bf16 v[144:147], v[208:211], a[132:135], v[144:147]
    v_fmac_f32 v14, v78, v34
    v_fmac_f32 v15, v79, v35
    s_waitcnt lgkmcnt(0)
    v_pk_fma_f32 v[8:9], v[128:129], v[28:29], v[8:9] op_sel:[0,0,0] op_sel_hi:[1,1,1]
    v_pk_fma_f32 v[10:11], v[130:131], v[30:31], v[10:11] op_sel:[0,0,0] op_sel_hi:[1,1,1]
    v_cvt_pk_bf16_f32 v48, v8, v9
    v_cvt_pk_bf16_f32 v49, v10, v11
    ds_write_b64 v4, v[48:49] offset:0
    v_pk_fma_f32 v[12:13], v[80:81], v[32:33], v[12:13] op_sel:[0,0,0] op_sel_hi:[1,1,1]
    v_pk_fma_f32 v[14:15], v[82:83], v[34:35], v[14:15] op_sel:[0,0,0] op_sel_hi:[1,1,1]
    v_pk_fma_f32 v[12:13], v[84:85], v[32:33], v[12:13] op_sel:[0,0,0] op_sel_hi:[1,1,1]
    v_pk_fma_f32 v[14:15], v[86:87], v[34:35], v[14:15] op_sel:[0,0,0] op_sel_hi:[1,1,1]
    v_pk_fma_f32 v[12:13], v[132:133], v[32:33], v[12:13] op_sel:[0,0,0] op_sel_hi:[1,1,1]
    v_pk_fma_f32 v[14:15], v[134:135], v[34:35], v[14:15] op_sel:[0,0,0] op_sel_hi:[1,1,1]
    v_cvt_pk_bf16_f32 v50, v12, v13
    v_cvt_pk_bf16_f32 v51, v14, v15
    ds_write_b64 v4, v[50:51] offset:640
    ds_read_b128 v[64:67], v2 offset:0
    v_pk_fma_f32 v[16:17], v[88:89], v[36:37], v[16:17] op_sel:[0,0,0] op_sel_hi:[1,1,1]
    v_pk_fma_f32 v[18:19], v[90:91], v[38:39], v[18:19] op_sel:[0,0,0] op_sel_hi:[1,1,1]
    v_pk_fma_f32 v[16:17], v[92:93], v[36:37], v[16:17] op_sel:[0,0,0] op_sel_hi:[1,1,1]
    v_pk_fma_f32 v[18:19], v[94:95], v[38:39], v[18:19] op_sel:[0,0,0] op_sel_hi:[1,1,1]
    v_pk_fma_f32 v[16:17], v[96:97], v[36:37], v[16:17] op_sel:[0,0,0] op_sel_hi:[1,1,1]
    v_pk_fma_f32 v[18:19], v[98:99], v[38:39], v[18:19] op_sel:[0,0,0] op_sel_hi:[1,1,1]
    v_pk_fma_f32 v[16:17], v[136:137], v[36:37], v[16:17] op_sel:[0,0,0] op_sel_hi:[1,1,1]
    v_pk_fma_f32 v[18:19], v[138:139], v[38:39], v[18:19] op_sel:[0,0,0] op_sel_hi:[1,1,1]
    v_cvt_pk_bf16_f32 v52, v16, v17
    v_cvt_pk_bf16_f32 v53, v18, v19
    ds_write_b64 v4, v[52:53] offset:1280
    v_pk_fma_f32 v[20:21], v[100:101], v[40:41], v[20:21] op_sel:[0,0,0] op_sel_hi:[1,1,1]
    v_pk_fma_f32 v[22:23], v[102:103], v[42:43], v[22:23] op_sel:[0,0,0] op_sel_hi:[1,1,1]
    v_pk_fma_f32 v[20:21], v[104:105], v[40:41], v[20:21] op_sel:[0,0,0] op_sel_hi:[1,1,1]
    v_pk_fma_f32 v[22:23], v[106:107], v[42:43], v[22:23] op_sel:[0,0,0] op_sel_hi:[1,1,1]
    v_pk_fma_f32 v[20:21], v[108:109], v[40:41], v[20:21] op_sel:[0,0,0] op_sel_hi:[1,1,1]
    v_pk_fma_f32 v[22:23], v[110:111], v[42:43], v[22:23] op_sel:[0,0,0] op_sel_hi:[1,1,1]
    v_pk_fma_f32 v[20:21], v[140:141], v[40:41], v[20:21] op_sel:[0,0,0] op_sel_hi:[1,1,1]
    v_pk_fma_f32 v[22:23], v[142:143], v[42:43], v[22:23] op_sel:[0,0,0] op_sel_hi:[1,1,1]
    v_cvt_pk_bf16_f32 v54, v20, v21
    v_cvt_pk_bf16_f32 v55, v22, v23
    ds_write_b64 v4, v[54:55] offset:1920
    ds_read_b128 v[88:91], v2 offset:1280
    s_waitcnt lgkmcnt(3)
    buffer_store_dwordx4 v[64:67], v1, s[8:11], s68 offen offset:0 nt
    v_pk_fma_f32 v[24:25], v[112:113], v[44:45], v[24:25] op_sel:[0,0,0] op_sel_hi:[1,1,1]
    v_pk_fma_f32 v[26:27], v[114:115], v[46:47], v[26:27] op_sel:[0,0,0] op_sel_hi:[1,1,1]
    v_pk_fma_f32 v[24:25], v[116:117], v[44:45], v[24:25] op_sel:[0,0,0] op_sel_hi:[1,1,1]
    v_pk_fma_f32 v[26:27], v[118:119], v[46:47], v[26:27] op_sel:[0,0,0] op_sel_hi:[1,1,1]
    v_pk_fma_f32 v[24:25], v[120:121], v[44:45], v[24:25] op_sel:[0,0,0] op_sel_hi:[1,1,1]
    v_pk_fma_f32 v[26:27], v[122:123], v[46:47], v[26:27] op_sel:[0,0,0] op_sel_hi:[1,1,1]
    v_pk_fma_f32 v[24:25], v[144:145], v[44:45], v[24:25] op_sel:[0,0,0] op_sel_hi:[1,1,1]
    v_pk_fma_f32 v[26:27], v[146:147], v[46:47], v[26:27] op_sel:[0,0,0] op_sel_hi:[1,1,1]
    v_cvt_pk_bf16_f32 v56, v24, v25
    v_cvt_pk_bf16_f32 v57, v26, v27
    ds_write_b64 v4, v[56:57] offset:2560
    ds_read_b128 v[112:115], v2 offset:2560
    s_waitcnt lgkmcnt(2)
    buffer_store_dwordx4 v[88:91], v1, s[8:11], s68 offen offset:64 nt
    s_mov_b32 exec_lo, 0x33333333
    s_mov_b32 exec_hi, 0x33333333
    s_waitcnt lgkmcnt(0)
    buffer_store_dwordx4 v[112:115], v1, s[8:11], s68 offen offset:128 nt
K_end:
    s_endpgm
K_slow9:
    s_cmp_eq_u32 s40, 0
    s_cbranch_scc1 K_back9
    buffer_load_dword v140, v138, s[60:63], 0 offen sc1
    s_sub_u32 s40, s40, 1
    s_waitcnt vmcnt(0)
    v_cmp_gt_u32 vcc, 1, v140
    s_nop 0
    s_cbranch_vccnz K_slow9
    s_branch K_back9
K_slow0:
    s_cmp_eq_u32 s40, 0
    s_cbranch_scc1 K_back0
    buffer_load_dwordx4 v[56:59], v61, s[16:19], 0 offen sc1
    s_sub_u32 s40, s40, 1
    s_waitcnt vmcnt(0)
    v_min3_u32 v56, v56, v57, v58
    v_min_u32 v56, v56, v59
    v_cmp_gt_u32 vcc, 1, v56
    s_nop 0
    s_cbranch_vccnz K_slow0
    s_branch K_back0
K_slow1:
    s_cmp_eq_u32 s40, 0
    s_cbranch_scc1 K_back1
    buffer_load_dword v124, v61, s[16:19], s70 offen sc1
    s_sub_u32 s40, s40, 1
    s_waitcnt vmcnt(0)
    v_cmp_ne_u32 vcc, 0x101, v124
    s_nop 0
    s_cbranch_vccnz K_slow1
    s_branch K_back1
K_slow2:
    s_cmp_eq_u32 s40, 0
    s_cbranch_scc1 K_back2
    buffer_load_dword v124, v126, s[16:19], s71 offen sc1
    s_sub_u32 s40, s40, 1
    s_waitcnt vmcnt(0)
    v_cmp_ne_u32 vcc, 0x101, v124
    s_nop 0
    s_cbranch_vccnz K_slow2
    s_branch K_back2
K_slow3:
    s_cmp_eq_u32 s40, 0
    s_cbranch_scc1 K_back3
    buffer_load_dword v124, v126, s[16:19], s71 offen sc1
    s_sub_u32 s40, s40, 1
    s_waitcnt vmcnt(0)
    v_cmp_ne_u32 vcc, 0x101, v124
    s_nop 0
    s_cbranch_vccnz K_slow3
    s_branch K_back3
K_slow4:
    s_cmp_eq_u32 s40, 0
    s_cbranch_scc1 K_back4
    buffer_load_dword v124, v126, s[16:19], s71 offen sc1
    s_sub_u32 s40, s40, 1
    s_waitcnt vmcnt(0)
    v_cmp_ne_u32 vcc, 0x101, v124
    s_nop 0
    s_cbranch_vccnz K_slow4
    s_branch K_back4
K_slow5:
    v_and_b32 v60, 0x380, v62
    s_cmp_eq_u32 s40, 0
    s_cbranch_scc1 K_back5
    buffer_load_dword v124, v60, s[16:19], s72 offen sc1
    s_sub_u32 s40, s40, 1
    s_waitcnt vmcnt(0)
    v_cmp_ne_u32 vcc, 0x1010101, v124
    s_nop 0
    s_cbranch_vccnz K_slow5
    s_branch K_back5
.p2align 8
.fill 4096, 4, 0xbf810000
.section .rodata,"a"
.p2align 6
.amdhsa_kernel recurrent_scan__sliding_local_dilated__swiglu_ffn__prompt_kernel
  .amdhsa_next_free_vgpr 512
  .amdhsa_next_free_sgpr 102
  .amdhsa_accum_offset 256
  .amdhsa_group_segment_fixed_size 0
  .amdhsa_kernarg_size 80
  .amdhsa_user_sgpr_count 2
  .amdhsa_user_sgpr_kernarg_segment_ptr 1
  .amdhsa_system_sgpr_workgroup_id_x 1
.end_amdhsa_kernel
```
